```python
import torch

def _softmax(x, axis=-1):
    return torch.softmax(x, dim=axis)
def _gelu(x):
    return torch.nn.functional.gelu(x, approximate="tanh")
def _silu(x):
    return torch.nn.functional.silu(x)
def _sigmoid(x):
    return torch.sigmoid(x)
def _layernorm(x, axis=-1, eps=1e-5):
    m = x.mean(dim=axis, keepdim=True)
    v = x.var(dim=axis, keepdim=True, unbiased=False)
    return (x - m) / torch.sqrt(v + eps)
def _scatter_add(tgt, idx, src, axis=0):
    return tgt.clone().index_add_(axis, idx, src)
def _segment_sum(src, seg, n):
    out = torch.zeros((n,) + src.shape[1:], dtype=src.dtype)
    return out.index_add_(0, seg, src)
def _pad(x, pw):
    flat = tuple(v for pair in reversed(pw) for v in pair)
    return torch.nn.functional.pad(x, flat)

kernel_name = 'standalone__detection_seg_mask2former__vision'

def setup_inputs():

    _w = (lambda a: (lambda t: t.to(torch.bfloat16) if t.is_floating_point() else t)(torch.as_tensor(a)))
    H = W = 224
    C = 192
    Hc, Wc = H // 2, W // 2
    nh = 4
    Nq = 16
    sc = C ** -0.5
    return {
        "q": _w((lambda *s: torch.randn(*s, dtype=torch.bfloat16) * 0.2)(1, Nq, C)),
        "f_hi": _w((lambda *s: torch.randn(*s, dtype=torch.bfloat16) * 0.2)(1, H, W, C)),
        "f_lo": _w((lambda *s: torch.randn(*s, dtype=torch.bfloat16) * 0.4)(1, Hc, Wc, C)),
        "w_lat": _w((lambda *s: torch.randn(*s, dtype=torch.bfloat16) * 0.4)(C, C) * sc),
        "w_q": _w((lambda *s: torch.randn(*s, dtype=torch.bfloat16) * 3.2)(nh, C, C // nh) * sc),
        "w_k": _w((lambda *s: torch.randn(*s, dtype=torch.bfloat16) * 3.2)(nh, C, C // nh) * sc),
        "w_v": _w((lambda *s: torch.randn(*s, dtype=torch.bfloat16) * 3.2)(nh, C, C // nh) * sc),
        "w_o": _w((lambda *s: torch.randn(*s, dtype=torch.bfloat16) * 3.2)(C, C) * sc),
        "w_m": _w((lambda *s: torch.randn(*s, dtype=torch.bfloat16) * 3.2)(C, C) * sc),
    }

def reference(q, f_hi, f_lo, w_lat, w_q, w_k, w_v, w_o, w_m):
    B, Nq, C = q.shape
    _, H, W, _ = f_hi.shape
    nh = w_q.shape[0]
    dh = C // nh
    up = (lambda x, n, axis: torch.repeat_interleave(x, n, dim=axis))((lambda x, n, axis: torch.repeat_interleave(x, n, dim=axis))(f_lo, 2, axis=1), 2, axis=2)
    feat = f_hi + up @ w_lat
    feat = _layernorm(feat, axis=-1)
    kv = feat.reshape(B, H * W, C)
    m_embed = q @ w_m
    mask_bias = torch.einsum('bqc,bkc->bqk', m_embed, kv) * (C ** -0.5)
    Q = torch.einsum('bqc,hcd->bhqd', q, w_q)
    K = torch.einsum('bkc,hcd->bhkd', kv, w_k)
    V = torch.einsum('bkc,hcd->bhkd', kv, w_v)
    logits = torch.einsum('bhqd,bhkd->bhqk', Q, K) * (dh ** -0.5)
    logits = logits + mask_bias[:, None, :, :]
    attn = _softmax(logits, axis=-1)
    ctx = torch.einsum('bhqk,bhkd->bqhd', attn, V).reshape(B, Nq, C)
    return q + ctx @ w_o
```

```asm
; @launch grid=(256,1,1) block=(512,1,1) lds=159744
.amdgcn_target "amdgcn-amd-amdhsa--gfx950"
.text
.globl standalone__detection_seg_mask2former__vision_kernel
.p2align 8
.type standalone__detection_seg_mask2former__vision_kernel,@function
standalone__detection_seg_mask2former__vision_kernel:
  s_cmp_ge_u32 s2, 256
  s_cbranch_scc1 K_END
  s_load_dwordx16 s[16:31], s[0:1], 0
  s_load_dwordx8 s[32:39], s[0:1], 64
  v_and_b32 v1, 63, v0
  v_lshrrev_b32 v8, 6, v0
  v_and_b32 v2, 15, v1
  v_readfirstlane_b32 s3, v8
  v_lshrrev_b32 v3, 4, v1
  v_and_b32 v4, 3, v1
  v_bfe_u32 v5, v1, 2, 2
  v_and_b32 v6, 7, v1
  v_lshrrev_b32 v7, 3, v1
  s_and_b32 s4, s3, 3
  s_lshr_b32 s5, s3, 2
  s_cmp_ge_u32 s2, 32
  s_cbranch_scc1 MAINROLE
  s_waitcnt lgkmcnt(0)
  s_mov_b32 s56, s38
  s_and_b32 s57, s39, 0xffff
  s_mov_b32 s58, 33554432
  s_mov_b32 s59, 0x20000
  s_load_dword s13, s[38:39], 0
  s_mov_b32 s40, s16
  s_and_b32 s41, s17, 0xffff
  s_mov_b32 s42, 6144
  s_mov_b32 s43, 0x20000
  s_mov_b32 s44, s24
  s_and_b32 s45, s25, 0xffff
  s_mov_b32 s46, 73728
  s_mov_b32 s47, 0x20000
  s_mov_b32 s48, s26
  s_and_b32 s49, s27, 0xffff
  s_mov_b32 s50, 73728
  s_mov_b32 s51, 0x20000
  s_mov_b32 s52, s32
  s_and_b32 s53, s33, 0xffff
  s_mov_b32 s54, 73728
  s_mov_b32 s55, 0x20000
  s_mov_b32 s8, s30
  s_and_b32 s9, s31, 0xffff
  s_mov_b32 s10, 73728
  s_mov_b32 s11, 0x20000
  s_mov_b32 s16, s34
  s_and_b32 s17, s35, 0xffff
  s_mov_b32 s18, 6144
  s_mov_b32 s19, 0x20000
  v_lshlrev_b32 v8, 4, v1
  s_mul_i32 s20, s2, 43
  s_lshr_b32 s20, s20, 8
  s_mul_i32 s21, s20, 6
  s_sub_u32 s21, s2, s21
  s_mul_i32 s22, s20, 18432
  s_mul_i32 s24, s2, 57344
  s_add_u32 s24, s24, 65536
  s_lshl_b32 s25, s2, 10
  s_add_u32 s25, s25, 4194304
  v_mov_b32 v12, -1
  v_mov_b32 v13, -1
  v_mov_b32 v14, -1
  v_mov_b32 v15, -1
  s_cmp_ge_u32 s2, 24
  s_cbranch_scc1 H_NOA
  s_lshl_b32 s60, s3, 10
  s_add_u32 s60, s60, 0
  s_mov_b32 m0, s60
  s_add_u32 s61, s60, s22
  buffer_load_dwordx4 v8, s[44:47], s61 offen lds
  s_lshl_b32 s60, s3, 10
  s_add_u32 s60, s60, 8192
  s_mov_b32 m0, s60
  s_add_u32 s61, s60, s22
  buffer_load_dwordx4 v8, s[44:47], s61 offen lds
  s_cmp_ge_u32 s3, 2
  s_cbranch_scc1 HS_3
  s_lshl_b32 s60, s3, 10
  s_add_u32 s60, s60, 16384
  s_mov_b32 m0, s60
  s_add_u32 s61, s60, s22
  buffer_load_dwordx4 v8, s[44:47], s61 offen lds
HS_3:
  v_lshrrev_b32 v9, 2, v1
  v_mul_u32_u24 v9, 384, v9
  v_lshl_add_u32 v9, v4, 4, v9
  s_add_u32 s60, s3, 0
  s_lshl_b32 s61, s60, 10
  s_add_u32 s61, s61, 18432
  s_mov_b32 m0, s61
  s_mul_i32 s61, s60, 6144
  s_lshl_b32 s62, s21, 6
  s_add_u32 s61, s61, s62
  buffer_load_dwordx4 v9, s[52:55], s61 offen lds
  s_cmp_ge_u32 s3, 4
  s_cbranch_scc1 HS_5
  s_add_u32 s60, s3, 8
  s_lshl_b32 s61, s60, 10
  s_add_u32 s61, s61, 18432
  s_mov_b32 m0, s61
  s_mul_i32 s61, s60, 6144
  s_lshl_b32 s62, s21, 6
  s_add_u32 s61, s61, s62
  buffer_load_dwordx4 v9, s[52:55], s61 offen lds
HS_5:
  s_cmp_ge_u32 s3, 6
  s_cbranch_scc1 HS_6
  s_lshl_b32 s60, s3, 10
  s_add_u32 s61, s60, 32768
  s_mov_b32 m0, s61
  s_nop 0
  buffer_load_dwordx4 v8, s[40:43], s60 offen lds
HS_6:
  s_cmp_lt_u32 s3, 5
  s_cbranch_scc1 HS_7
  s_sub_u32 s60, s3, 5
  s_lshl_b32 s60, s60, 10
  s_add_u32 s61, s60, 38912
  s_mov_b32 m0, s61
  s_mul_i32 s61, s21, 3072
  s_add_u32 s61, s61, s22
  s_add_u32 s61, s61, s60
  buffer_load_dwordx4 v8, s[48:51], s61 offen lds
HS_7:
  v_mul_u32_u24 v10, 384, v2
  v_lshl_add_u32 v10, v3, 4, v10
  v_lshrrev_b32 v11, 2, v2
  v_lshlrev_b32 v11, 3, v11
  v_add_u32 v11, v11, v4
  v_mul_u32_u24 v11, 96, v11
  v_lshl_add_u32 v11, v3, 3, v11
  s_waitcnt vmcnt(0)
  s_barrier
  v_lshl_add_u32 v16, v3, 3, v5
  v_mul_u32_u24 v17, 96, v16
  v_lshl_add_u32 v17, v4, 3, v17
  s_lshl_b32 s60, s3, 5
  v_add_u32 v17, s60, v17
  v_lshlrev_b32 v18, 6, v16
  v_lshl_add_u32 v18, v4, 4, v18
  s_cmp_ge_u32 s3, 4
  s_cbranch_scc1 H_A_SKIP1
  ds_read_b128 v[32:35], v10 offset:32768
  ds_read_b128 v[36:39], v10 offset:32832
  ds_read_b128 v[40:43], v10 offset:32896
  ds_read_b128 v[44:47], v10 offset:32960
  ds_read_b128 v[48:51], v10 offset:33024
  ds_read_b128 v[52:55], v10 offset:33088
  s_cmp_eq_u32 s3, 3
  s_cbranch_scc1 H_A_M
  ds_read_b64_tr_b16 v[64:65], v17 offset:0
  ds_read_b64_tr_b16 v[66:67], v17 offset:384
  ds_read_b64_tr_b16 v[68:69], v17 offset:3072
  ds_read_b64_tr_b16 v[70:71], v17 offset:3456
  ds_read_b64_tr_b16 v[72:73], v17 offset:6144
  ds_read_b64_tr_b16 v[74:75], v17 offset:6528
  ds_read_b64_tr_b16 v[76:77], v17 offset:9216
  ds_read_b64_tr_b16 v[78:79], v17 offset:9600
  ds_read_b64_tr_b16 v[80:81], v17 offset:12288
  ds_read_b64_tr_b16 v[82:83], v17 offset:12672
  ds_read_b64_tr_b16 v[84:85], v17 offset:15360
  ds_read_b64_tr_b16 v[86:87], v17 offset:15744
  s_waitcnt lgkmcnt(10)
  v_mfma_f32_16x16x32_bf16 v[88:91], v[64:67], v[32:35], 0
  s_waitcnt lgkmcnt(8)
  v_mfma_f32_16x16x32_bf16 v[88:91], v[68:71], v[36:39], v[88:91]
  s_waitcnt lgkmcnt(6)
  v_mfma_f32_16x16x32_bf16 v[88:91], v[72:75], v[40:43], v[88:91]
  s_waitcnt lgkmcnt(4)
  v_mfma_f32_16x16x32_bf16 v[88:91], v[76:79], v[44:47], v[88:91]
  s_waitcnt lgkmcnt(2)
  v_mfma_f32_16x16x32_bf16 v[88:91], v[80:83], v[48:51], v[88:91]
  s_waitcnt lgkmcnt(0)
  v_mfma_f32_16x16x32_bf16 v[88:91], v[84:87], v[52:55], v[88:91]
  s_nop 7
  v_cvt_pk_bf16_f32 v92, v88, v89
  v_cvt_pk_bf16_f32 v93, v90, v91
  s_lshl_b32 s60, s3, 9
  s_add_u32 s60, s60, 30720
  v_lshl_add_u32 v19, v1, 3, s60
  ds_write_b64 v19, v[92:93]
  s_waitcnt lgkmcnt(0)
  s_branch H_A_SKIP1
H_A_M:
  ds_read_b64 v[56:57], v11 offset:38912
  ds_read_b64 v[58:59], v11 offset:38944
  ds_read_b64 v[60:61], v11 offset:38976
  v_mov_b32 v62, 0
  v_mov_b32 v63, 0
  ds_read_b64 v[108:109], v11 offset:39296
  ds_read_b64 v[110:111], v11 offset:39328
  ds_read_b64 v[112:113], v11 offset:39360
  v_mov_b32 v114, 0
  v_mov_b32 v115, 0
  ds_read_b64_tr_b16 v[64:65], v18 offset:18432
  ds_read_b64_tr_b16 v[66:67], v18 offset:18688
  ds_read_b64_tr_b16 v[116:117], v18 offset:18440
  ds_read_b64_tr_b16 v[118:119], v18 offset:18696
  ds_read_b64_tr_b16 v[68:69], v18 offset:20480
  ds_read_b64_tr_b16 v[70:71], v18 offset:20736
  ds_read_b64_tr_b16 v[120:121], v18 offset:20488
  ds_read_b64_tr_b16 v[122:123], v18 offset:20744
  ds_read_b64_tr_b16 v[72:73], v18 offset:22528
  ds_read_b64_tr_b16 v[74:75], v18 offset:22784
  ds_read_b64_tr_b16 v[124:125], v18 offset:22536
  ds_read_b64_tr_b16 v[126:127], v18 offset:22792
  ds_read_b64_tr_b16 v[76:77], v18 offset:24576
  ds_read_b64_tr_b16 v[78:79], v18 offset:24832
  ds_read_b64_tr_b16 v[128:129], v18 offset:24584
  ds_read_b64_tr_b16 v[130:131], v18 offset:24840
  ds_read_b64_tr_b16 v[80:81], v18 offset:26624
  ds_read_b64_tr_b16 v[82:83], v18 offset:26880
  ds_read_b64_tr_b16 v[132:133], v18 offset:26632
  ds_read_b64_tr_b16 v[134:135], v18 offset:26888
  ds_read_b64_tr_b16 v[84:85], v18 offset:28672
  ds_read_b64_tr_b16 v[86:87], v18 offset:28928
  ds_read_b64_tr_b16 v[136:137], v18 offset:28680
  ds_read_b64_tr_b16 v[138:139], v18 offset:28936
  s_waitcnt lgkmcnt(15)
  v_mfma_f32_16x16x32_bf16 v[88:91], v[64:67], v[32:35], 0
  s_waitcnt lgkmcnt(15)
  v_mfma_f32_16x16x32_bf16 v[92:95], v[116:119], v[32:35], 0
  s_waitcnt lgkmcnt(15)
  v_mfma_f32_16x16x32_bf16 v[88:91], v[68:71], v[36:39], v[88:91]
  s_waitcnt lgkmcnt(15)
  v_mfma_f32_16x16x32_bf16 v[92:95], v[120:123], v[36:39], v[92:95]
  s_waitcnt lgkmcnt(14)
  v_mfma_f32_16x16x32_bf16 v[88:91], v[72:75], v[40:43], v[88:91]
  s_waitcnt lgkmcnt(12)
  v_mfma_f32_16x16x32_bf16 v[92:95], v[124:127], v[40:43], v[92:95]
  s_waitcnt lgkmcnt(10)
  v_mfma_f32_16x16x32_bf16 v[88:91], v[76:79], v[44:47], v[88:91]
  s_waitcnt lgkmcnt(8)
  v_mfma_f32_16x16x32_bf16 v[92:95], v[128:131], v[44:47], v[92:95]
  s_waitcnt lgkmcnt(6)
  v_mfma_f32_16x16x32_bf16 v[88:91], v[80:83], v[48:51], v[88:91]
  s_waitcnt lgkmcnt(4)
  v_mfma_f32_16x16x32_bf16 v[92:95], v[132:135], v[48:51], v[92:95]
  s_waitcnt lgkmcnt(2)
  v_mfma_f32_16x16x32_bf16 v[88:91], v[84:87], v[52:55], v[88:91]
  s_waitcnt lgkmcnt(0)
  v_mfma_f32_16x16x32_bf16 v[92:95], v[136:139], v[52:55], v[92:95]
  s_waitcnt lgkmcnt(0)
H_A_SKIP1:
  s_barrier
  s_cmp_lg_u32 s3, 3
  s_cbranch_scc1 H_CLEAR
  v_lshlrev_b32 v19, 3, v1
  ds_read_b64 v[96:97], v19 offset:30720
  ds_read_b64 v[98:99], v19 offset:31232
  ds_read_b64 v[100:101], v19 offset:31744
  v_mov_b32 v102, 0
  v_mov_b32 v103, 0
  s_mov_b32 s60, 0x3e553b95
  s_mov_b32 s61, 0x3dd53b95
  v_cvt_pk_bf16_f32 v140, v88, v89
  v_lshlrev_b32 v88, 16, v140
  v_and_b32 v89, 0xffff0000, v140
  v_cvt_pk_bf16_f32 v141, v90, v91
  v_lshlrev_b32 v90, 16, v141
  v_and_b32 v91, 0xffff0000, v141
  v_cvt_pk_bf16_f32 v142, v92, v93
  v_lshlrev_b32 v92, 16, v142
  v_and_b32 v93, 0xffff0000, v142
  v_cvt_pk_bf16_f32 v143, v94, v95
  v_lshlrev_b32 v94, 16, v143
  v_and_b32 v95, 0xffff0000, v143
  v_mul_f32 v88, s61, v88
  v_mul_f32 v89, s61, v89
  v_mul_f32 v90, s61, v90
  v_mul_f32 v91, s61, v91
  v_mul_f32 v92, s61, v92
  v_mul_f32 v93, s61, v93
  v_mul_f32 v94, s61, v94
  v_mul_f32 v95, s61, v95
  s_waitcnt lgkmcnt(1)
  v_mfma_f32_16x16x32_bf16 v[144:147], v[56:59], v[96:99], 0
  s_waitcnt lgkmcnt(0)
  v_mfma_f32_16x16x32_bf16 v[144:147], v[60:63], v[100:103], v[144:147]
  v_mfma_f32_16x16x32_bf16 v[148:151], v[108:111], v[96:99], 0
  v_mfma_f32_16x16x32_bf16 v[148:151], v[112:115], v[100:103], v[148:151]
  s_nop 5
  v_fma_f32 v88, v144, s60, v88
  v_fma_f32 v89, v145, s60, v89
  v_fma_f32 v90, v146, s60, v90
  v_fma_f32 v91, v147, s60, v91
  v_fma_f32 v92, v148, s60, v92
  v_fma_f32 v93, v149, s60, v93
  v_fma_f32 v94, v150, s60, v94
  v_fma_f32 v95, v151, s60, v95
  v_cvt_pk_bf16_f32 v140, v88, v89
  v_cvt_pk_bf16_f32 v141, v90, v91
  v_cvt_pk_bf16_f32 v142, v92, v93
  v_cvt_pk_bf16_f32 v143, v94, v95
  s_waitcnt lgkmcnt(0)
  s_mul_i32 s14, s13, 0x9E3779B1
  s_add_u32 s14, s14, 0x7F4A7C15
  v_bitop3_b32 v19, v140, v141, v142 bitop3:0x96
  v_bitop3_b32 v19, v19, v143, s14 bitop3:0x96
  s_lshl_b32 s60, s2, 10
  s_add_u32 s60, s60, 8192
  buffer_store_dwordx4 v[140:143], v8, s[56:59], s60 offen sc1
  s_lshl_b32 s60, s2, 8
  s_add_u32 s60, s60, 32768
  v_lshlrev_b32 v16, 2, v1
  buffer_store_dword v19, v16, s[56:59], s60 offen sc1
  s_branch H_CLEARED
H_NOA:
  s_cmp_eq_u32 s3, 3
  s_cbranch_scc1 H_CLEARED
H_CLEAR:
  s_cmp_gt_u32 s3, 3
  s_cselect_b32 s61, 1, 0
  s_sub_u32 s60, s3, s61
  s_lshl_b32 s60, s60, 13
  s_add_u32 s60, s60, s24
  buffer_store_dwordx4 v[12:15], v8, s[56:59], s60 offen offset:0 sc1
  buffer_store_dwordx4 v[12:15], v8, s[56:59], s60 offen offset:1024 sc1
  buffer_store_dwordx4 v[12:15], v8, s[56:59], s60 offen offset:2048 sc1
  buffer_store_dwordx4 v[12:15], v8, s[56:59], s60 offen offset:3072 sc1
  s_add_u32 s60, s60, 4096
  buffer_store_dwordx4 v[12:15], v8, s[56:59], s60 offen offset:0 sc1
  buffer_store_dwordx4 v[12:15], v8, s[56:59], s60 offen offset:1024 sc1
  buffer_store_dwordx4 v[12:15], v8, s[56:59], s60 offen offset:2048 sc1
  buffer_store_dwordx4 v[12:15], v8, s[56:59], s60 offen offset:3072 sc1
  s_cmp_lg_u32 s3, 0
  s_cbranch_scc1 HS_8
  buffer_store_dwordx4 v[12:15], v8, s[56:59], s25 offen sc1
HS_8:
H_CLEARED:
  s_waitcnt vmcnt(0) lgkmcnt(0)
  s_barrier
  s_mul_i32 s14, s13, 0x9E3779B1
  s_add_u32 s14, s14, 0x7F4A7C15
  s_cmp_lg_u32 s3, 0
  s_cbranch_scc1 HS_9
  v_lshlrev_b32 v16, 7, v1
  v_mov_b32 v17, s14
  s_lshl_b32 s60, s2, 2
  s_add_u32 s60, s60, 4096
  v_cmp_gt_u32 vcc, 16, v1
  s_nop 0
  s_and_saveexec_b64 s[62:63], vcc
  buffer_store_dword v17, v16, s[56:59], s60 offen sc1
  s_mov_b64 exec, s[62:63]
HS_9:
  s_and_b32 s26, s2, 1
  s_lshr_b32 s27, s2, 1
  s_mul_i32 s28, s26, 36864
  s_lshl_b32 s60, s3, 10
  s_add_u32 s60, s60, 0
  s_mov_b32 m0, s60
  s_add_u32 s61, s60, s28
  buffer_load_dwordx4 v8, s[8:11], s61 offen lds
  s_lshl_b32 s60, s3, 10
  s_add_u32 s60, s60, 8192
  s_mov_b32 m0, s60
  s_add_u32 s61, s60, s28
  buffer_load_dwordx4 v8, s[8:11], s61 offen lds
  s_lshl_b32 s60, s3, 10
  s_add_u32 s60, s60, 16384
  s_mov_b32 m0, s60
  s_add_u32 s61, s60, s28
  buffer_load_dwordx4 v8, s[8:11], s61 offen lds
  s_lshl_b32 s60, s3, 10
  s_add_u32 s60, s60, 24576
  s_mov_b32 m0, s60
  s_add_u32 s61, s60, s28
  buffer_load_dwordx4 v8, s[8:11], s61 offen lds
  s_cmp_ge_u32 s3, 4
  s_cbranch_scc1 HS_14
  s_lshl_b32 s60, s3, 10
  s_add_u32 s60, s60, 32768
  s_mov_b32 m0, s60
  s_add_u32 s61, s60, s28
  buffer_load_dwordx4 v8, s[8:11], s61 offen lds
HS_14:
  s_mul_i32 s60, s27, 384
  s_lshl_b32 s61, s3, 6
  s_add_u32 s60, s60, s61
  v_lshlrev_b32 v16, 3, v3
  buffer_load_dwordx2 v[20:21], v16, s[40:43], s60 offen
  buffer_load_dwordx2 v[22:23], v16, s[40:43], s60 offen offset:32
  s_mov_b32 s29, s60
  s_waitcnt vmcnt(0)
  s_barrier
  v_lshl_add_u32 v16, v3, 2, v5
  v_mul_u32_u24 v16, 384, v16
  v_lshl_add_u32 v16, v4, 3, v16
  s_lshl_b32 s60, s3, 6
  v_add_u32 v16, s60, v16
  ds_read_b64_tr_b16 v[100:101], v16 offset:0
  ds_read_b64_tr_b16 v[102:103], v16 offset:6144
  ds_read_b64_tr_b16 v[104:105], v16 offset:12288
  v_mov_b32 v106, 0
  v_mov_b32 v107, 0
  ds_read_b64_tr_b16 v[108:109], v16 offset:18432
  ds_read_b64_tr_b16 v[110:111], v16 offset:24576
  ds_read_b64_tr_b16 v[112:113], v16 offset:30720
  v_mov_b32 v114, 0
  v_mov_b32 v115, 0
  ds_read_b64_tr_b16 v[116:117], v16 offset:32
  ds_read_b64_tr_b16 v[118:119], v16 offset:6176
  ds_read_b64_tr_b16 v[120:121], v16 offset:12320
  v_mov_b32 v122, 0
  v_mov_b32 v123, 0
  ds_read_b64_tr_b16 v[124:125], v16 offset:18464
  ds_read_b64_tr_b16 v[126:127], v16 offset:24608
  ds_read_b64_tr_b16 v[128:129], v16 offset:30752
  v_mov_b32 v130, 0
  v_mov_b32 v131, 0
  v_and_b32 v24, 1, v2
  v_lshlrev_b32 v24, 4, v24
  v_mov_b32 v25, 0x3f80
  v_lshlrev_b32 v25, v24, v25
  v_lshrrev_b32 v26, 1, v2
  v_cmp_eq_u32 vcc, 0, v26
  s_nop 1
  v_cndmask_b32 v64, 0, v25, vcc
  v_cmp_eq_u32 vcc, 1, v26
  s_nop 1
  v_cndmask_b32 v65, 0, v25, vcc
  v_cmp_eq_u32 vcc, 2, v26
  s_nop 1
  v_cndmask_b32 v66, 0, v25, vcc
  v_cmp_eq_u32 vcc, 3, v26
  s_nop 1
  v_cndmask_b32 v67, 0, v25, vcc
  v_mov_b32 v60, 0
  v_mov_b32 v61, 0
  v_mov_b32 v62, 0
  v_mov_b32 v63, 0
  s_waitcnt lgkmcnt(0)
  v_lshlrev_b32 v17, 2, v1
  s_mul_i32 s30, s3, 7168
  s_add_u32 s30, s30, s24
  s_add_u32 s31, s30, 4096
  s_mov_b32 s12, 0
  s_mov_b32 s28, 0x7f
  s_mov_b32 s34, 0xf0f0f0f0
  s_mov_b32 s35, 0xf0f0f0f0
H_GATE:
  buffer_load_dword v68, v17, s[56:59], s30 offen sc1
  s_waitcnt vmcnt(0)
  v_cmp_eq_u32 vcc, -1, v68
  s_cbranch_vccz H_SWEEP
  s_add_u32 s12, s12, 1
  s_cmp_gt_u32 s12, 20000
  s_cbranch_scc1 H_SWEEP
  s_sleep 1
  s_branch H_GATE
H_SWEEP:
  s_bitcmp0_b32 s28, 0
  s_cbranch_scc1 H_L0
  buffer_load_dwordx4 v[32:35], v8, s[56:59], s30 offen offset:0 sc1
H_L0:
  s_bitcmp0_b32 s28, 1
  s_cbranch_scc1 H_L1
  buffer_load_dwordx4 v[36:39], v8, s[56:59], s30 offen offset:1024 sc1
H_L1:
  s_bitcmp0_b32 s28, 2
  s_cbranch_scc1 H_L2
  buffer_load_dwordx4 v[40:43], v8, s[56:59], s30 offen offset:2048 sc1
H_L2:
  s_bitcmp0_b32 s28, 3
  s_cbranch_scc1 H_L3
  buffer_load_dwordx4 v[44:47], v8, s[56:59], s30 offen offset:3072 sc1
H_L3:
  s_bitcmp0_b32 s28, 4
  s_cbranch_scc1 H_L4
  buffer_load_dwordx4 v[48:51], v8, s[56:59], s31 offen offset:0 sc1
H_L4:
  s_bitcmp0_b32 s28, 5
  s_cbranch_scc1 H_L5
  buffer_load_dwordx4 v[52:55], v8, s[56:59], s31 offen offset:1024 sc1
H_L5:
  s_bitcmp0_b32 s28, 6
  s_cbranch_scc1 H_L6
  buffer_load_dwordx4 v[56:59], v8, s[56:59], s31 offen offset:2048 sc1
H_L6:
  s_waitcnt vmcnt(0)
  s_bitcmp0_b32 s28, 0
  s_cbranch_scc1 H_C0
  v_max3_u32 v68, v32, v33, v34
  v_max_u32 v68, v68, v35
  v_cmp_eq_u32 vcc, -1, v68
  s_cbranch_vccnz H_C0
  v_cmp_ne_u32 vcc, 0, v35
  s_nop 0
  s_and_b64 vcc, vcc, s[34:35]
  s_cbranch_vccnz H_SAFE
  s_bitset0_b32 s28, 0
  v_mfma_f32_16x16x32_bf16 v[60:63], v[64:67], v[32:35], v[60:63]
H_C0:
  s_bitcmp0_b32 s28, 1
  s_cbranch_scc1 H_C1
  v_max3_u32 v68, v36, v37, v38
  v_max_u32 v68, v68, v39
  v_cmp_eq_u32 vcc, -1, v68
  s_cbranch_vccnz H_C1
  v_cmp_ne_u32 vcc, 0, v39
  s_nop 0
  s_and_b64 vcc, vcc, s[34:35]
  s_cbranch_vccnz H_SAFE
  s_bitset0_b32 s28, 1
  v_mfma_f32_16x16x32_bf16 v[60:63], v[64:67], v[36:39], v[60:63]
H_C1:
  s_bitcmp0_b32 s28, 2
  s_cbranch_scc1 H_C2
  v_max3_u32 v68, v40, v41, v42
  v_max_u32 v68, v68, v43
  v_cmp_eq_u32 vcc, -1, v68
  s_cbranch_vccnz H_C2
  v_cmp_ne_u32 vcc, 0, v43
  s_nop 0
  s_and_b64 vcc, vcc, s[34:35]
  s_cbranch_vccnz H_SAFE
  s_bitset0_b32 s28, 2
  v_mfma_f32_16x16x32_bf16 v[60:63], v[64:67], v[40:43], v[60:63]
H_C2:
  s_bitcmp0_b32 s28, 3
  s_cbranch_scc1 H_C3
  v_max3_u32 v68, v44, v45, v46
  v_max_u32 v68, v68, v47
  v_cmp_eq_u32 vcc, -1, v68
  s_cbranch_vccnz H_C3
  v_cmp_ne_u32 vcc, 0, v47
  s_nop 0
  s_and_b64 vcc, vcc, s[34:35]
  s_cbranch_vccnz H_SAFE
  s_bitset0_b32 s28, 3
  v_mfma_f32_16x16x32_bf16 v[60:63], v[64:67], v[44:47], v[60:63]
H_C3:
  s_bitcmp0_b32 s28, 4
  s_cbranch_scc1 H_C4
  v_max3_u32 v68, v48, v49, v50
  v_max_u32 v68, v68, v51
  v_cmp_eq_u32 vcc, -1, v68
  s_cbranch_vccnz H_C4
  v_cmp_ne_u32 vcc, 0, v51
  s_nop 0
  s_and_b64 vcc, vcc, s[34:35]
  s_cbranch_vccnz H_SAFE
  s_bitset0_b32 s28, 4
  v_mfma_f32_16x16x32_bf16 v[60:63], v[64:67], v[48:51], v[60:63]
H_C4:
  s_bitcmp0_b32 s28, 5
  s_cbranch_scc1 H_C5
  v_max3_u32 v68, v52, v53, v54
  v_max_u32 v68, v68, v55
  v_cmp_eq_u32 vcc, -1, v68
  s_cbranch_vccnz H_C5
  v_cmp_ne_u32 vcc, 0, v55
  s_nop 0
  s_and_b64 vcc, vcc, s[34:35]
  s_cbranch_vccnz H_SAFE
  s_bitset0_b32 s28, 5
  v_mfma_f32_16x16x32_bf16 v[60:63], v[64:67], v[52:55], v[60:63]
H_C5:
  s_bitcmp0_b32 s28, 6
  s_cbranch_scc1 H_C6
  v_max3_u32 v68, v56, v57, v58
  v_max_u32 v68, v68, v59
  v_cmp_eq_u32 vcc, -1, v68
  s_cbranch_vccnz H_C6
  v_cmp_ne_u32 vcc, 0, v59
  s_nop 0
  s_and_b64 vcc, vcc, s[34:35]
  s_cbranch_vccnz H_SAFE
  s_bitset0_b32 s28, 6
  v_mfma_f32_16x16x32_bf16 v[60:63], v[64:67], v[56:59], v[60:63]
H_C6:
  s_cmp_eq_u32 s28, 0
  s_cbranch_scc1 H_SWEPT
  s_add_u32 s12, s12, 1
  s_cmp_gt_u32 s12, 20000
  s_cbranch_scc1 H_SWEPT
  s_branch H_SWEEP
H_SWEPT:
  s_nop 7
  s_lshl_b32 s60, s3, 10
  s_add_u32 s60, s60, 40960
  v_add_u32 v18, s60, v8
  ds_write_b128 v18, v[60:63]
  s_waitcnt lgkmcnt(0)
  s_barrier
  s_cmp_ge_u32 s3, 6
  s_cbranch_scc1 H_END
  ds_read_b128 v[64:67], v8 offset:40960
  ds_read_b128 v[68:71], v8 offset:41984
  ds_read_b128 v[72:75], v8 offset:43008
  ds_read_b128 v[76:79], v8 offset:44032
  ds_read_b128 v[80:83], v8 offset:45056
  ds_read_b128 v[84:87], v8 offset:46080
  ds_read_b128 v[88:91], v8 offset:47104
  ds_read_b128 v[92:95], v8 offset:48128
  s_waitcnt lgkmcnt(6)
  v_add_f32 v64, v64, v68
  s_waitcnt lgkmcnt(4)
  v_add_f32 v72, v72, v76
  s_waitcnt lgkmcnt(2)
  v_add_f32 v80, v80, v84
  s_waitcnt lgkmcnt(0)
  v_add_f32 v88, v88, v92
  v_add_f32 v65, v65, v69
  v_add_f32 v73, v73, v77
  v_add_f32 v81, v81, v85
  v_add_f32 v89, v89, v93
  v_add_f32 v66, v66, v70
  v_add_f32 v74, v74, v78
  v_add_f32 v82, v82, v86
  v_add_f32 v90, v90, v94
  v_add_f32 v67, v67, v71
  v_add_f32 v75, v75, v79
  v_add_f32 v83, v83, v87
  v_add_f32 v91, v91, v95
  v_add_f32 v64, v64, v72
  v_add_f32 v80, v80, v88
  v_add_f32 v65, v65, v73
  v_add_f32 v81, v81, v89
  v_add_f32 v66, v66, v74
  v_add_f32 v82, v82, v90
  v_add_f32 v67, v67, v75
  v_add_f32 v83, v83, v91
  v_add_f32 v64, v64, v80
  v_add_f32 v65, v65, v81
  v_add_f32 v66, v66, v82
  v_add_f32 v67, v67, v83
  v_add_f32 v68, v64, v65
  s_nop 0
  v_readlane_b32 s60, v68, 20
  v_readlane_b32 s61, v68, 28
  s_nop 0
  v_mov_b32 v69, s60
  v_mov_b32 v70, s61
  v_and_b32 v71, 8, v1
  v_cmp_eq_u32 vcc, 0, v71
  s_nop 1
  v_cndmask_b32 v69, v70, v69, vcc
  v_rcp_f32 v69, v69
  s_nop 0
  v_mul_f32 v64, v64, v69
  v_mul_f32 v65, v65, v69
  v_mul_f32 v66, v66, v69
  v_mul_f32 v67, v67, v69
  v_cvt_pk_bf16_f32 v64, v64, v65
  v_cvt_pk_bf16_f32 v65, v66, v67
  v_and_b32 v66, 0x14, v1
  v_cmp_eq_u32 vcc, 0x14, v66
  s_nop 1
  v_cndmask_b32 v64, v64, 0, vcc
  v_cndmask_b32 v65, v65, 0, vcc
  s_lshl_b32 s60, s3, 8
  s_add_u32 s60, s60, 49152
  v_lshlrev_b32 v18, 4, v2
  v_lshl_add_u32 v18, v3, 3, v18
  v_add_u32 v18, s60, v18
  v_cmp_gt_u32 vcc, 32, v1
  s_nop 0
  s_and_saveexec_b64 s[62:63], vcc
  ds_write_b64 v18, v[64:65]
  s_mov_b64 exec, s[62:63]
  v_lshl_add_u32 v19, v3, 4, s60
  s_waitcnt lgkmcnt(0)
  ds_read_b128 v[68:71], v19 offset:0
  ds_read_b128 v[72:75], v19 offset:64
  ds_read_b128 v[76:79], v19 offset:128
  ds_read_b128 v[80:83], v19 offset:192
  s_waitcnt lgkmcnt(3)
  v_mfma_f32_16x16x32_bf16 v[84:87], v[100:103], v[68:71], 0
  v_mfma_f32_16x16x32_bf16 v[88:91], v[116:119], v[68:71], 0
  s_waitcnt lgkmcnt(2)
  v_mfma_f32_16x16x32_bf16 v[84:87], v[104:107], v[72:75], v[84:87]
  v_mfma_f32_16x16x32_bf16 v[88:91], v[120:123], v[72:75], v[88:91]
  s_waitcnt lgkmcnt(1)
  v_mfma_f32_16x16x32_bf16 v[84:87], v[108:111], v[76:79], v[84:87]
  v_mfma_f32_16x16x32_bf16 v[88:91], v[124:127], v[76:79], v[88:91]
  s_waitcnt lgkmcnt(0)
  v_mfma_f32_16x16x32_bf16 v[84:87], v[112:115], v[80:83], v[84:87]
  v_mfma_f32_16x16x32_bf16 v[88:91], v[128:131], v[80:83], v[88:91]
  s_cmp_ge_u32 s3, 3
  s_cselect_b32 s60, 1, 0
  s_mul_i32 s61, s60, 3
  s_sub_u32 s61, s3, s61
  s_lshl_b32 s61, s61, 7
  v_lshlrev_b32 v16, 4, v3
  v_cmp_eq_u32 vcc, 0, v2
  s_nop 0
  s_and_saveexec_b64 s[62:63], vcc
  s_cmp_eq_u32 s60, s26
  s_cbranch_scc1 H_RECV
  s_xor_b32 s60, s2, 1
  s_lshl_b32 s60, s60, 10
  s_add_u32 s60, s60, s61
  s_add_u32 s60, s60, 4194304
  v_min_u32 v84, 0xfffffffe, v84
  v_min_u32 v85, 0xfffffffe, v85
  v_min_u32 v86, 0xfffffffe, v86
  v_min_u32 v87, 0xfffffffe, v87
  v_min_u32 v88, 0xfffffffe, v88
  v_min_u32 v89, 0xfffffffe, v89
  v_min_u32 v90, 0xfffffffe, v90
  v_min_u32 v91, 0xfffffffe, v91
  buffer_store_dwordx4 v[84:87], v16, s[56:59], s60 offen sc1
  buffer_store_dwordx4 v[88:91], v16, s[56:59], s60 offen offset:64 sc1
  s_branch H_END
H_RECV:
  s_add_u32 s60, s25, s61
H_RPOLL:
  buffer_load_dwordx4 v[92:95], v16, s[56:59], s60 offen sc1
  buffer_load_dwordx4 v[96:99], v16, s[56:59], s60 offen offset:64 sc1
  s_waitcnt vmcnt(0)
  v_max3_u32 v68, v92, v93, v94
  v_max3_u32 v68, v68, v95, v96
  v_max3_u32 v68, v68, v97, v98
  v_max_u32 v68, v68, v99
  v_cmp_eq_u32 vcc, -1, v68
  s_cbranch_vccz H_RDONE
  s_add_u32 s12, s12, 1
  s_cmp_gt_u32 s12, 20000
  s_cbranch_scc0 H_RPOLL
H_RDONE:
  v_add_f32 v84, v84, v92
  v_add_f32 v85, v85, v93
  v_add_f32 v86, v86, v94
  v_add_f32 v87, v87, v95
  v_add_f32 v88, v88, v96
  v_add_f32 v89, v89, v97
  v_add_f32 v90, v90, v98
  v_add_f32 v91, v91, v99
  v_cvt_pk_bf16_f32 v92, v84, v85
  v_cvt_pk_bf16_f32 v93, v86, v87
  v_lshlrev_b32 v84, 16, v92
  v_and_b32 v85, 0xffff0000, v92
  v_lshlrev_b32 v86, 16, v93
  v_and_b32 v87, 0xffff0000, v93
  v_lshlrev_b32 v94, 16, v20
  v_and_b32 v95, 0xffff0000, v20
  v_lshlrev_b32 v96, 16, v21
  v_and_b32 v97, 0xffff0000, v21
  v_add_f32 v84, v84, v94
  v_add_f32 v85, v85, v95
  v_add_f32 v86, v86, v96
  v_add_f32 v87, v87, v97
  v_cvt_pk_bf16_f32 v100, v84, v85
  v_cvt_pk_bf16_f32 v101, v86, v87
  v_cvt_pk_bf16_f32 v92, v88, v89
  v_cvt_pk_bf16_f32 v93, v90, v91
  v_lshlrev_b32 v88, 16, v92
  v_and_b32 v89, 0xffff0000, v92
  v_lshlrev_b32 v90, 16, v93
  v_and_b32 v91, 0xffff0000, v93
  v_lshlrev_b32 v94, 16, v22
  v_and_b32 v95, 0xffff0000, v22
  v_lshlrev_b32 v96, 16, v23
  v_and_b32 v97, 0xffff0000, v23
  v_add_f32 v88, v88, v94
  v_add_f32 v89, v89, v95
  v_add_f32 v90, v90, v96
  v_add_f32 v91, v91, v97
  v_cvt_pk_bf16_f32 v102, v88, v89
  v_cvt_pk_bf16_f32 v103, v90, v91
  v_lshlrev_b32 v16, 3, v3
  buffer_store_dwordx2 v[100:101], v16, s[16:19], s29 offen
  buffer_store_dwordx2 v[102:103], v16, s[16:19], s29 offen offset:32
  s_or_b32 s60, s2, s3
  s_cmp_lg_u32 s60, 0
  s_cbranch_scc1 H_END
  s_mov_b64 exec, 1
  s_add_u32 s60, s13, 1
  v_mov_b32 v16, s60
  v_mov_b32 v17, 0
  buffer_store_dword v16, v17, s[56:59], 0 offen offset:0 sc1
  s_branch H_END
H_SAFE:
  s_waitcnt vmcnt(0)
H_SAFE_SW:
  buffer_load_dwordx4 v[32:35], v8, s[56:59], s30 offen offset:0 sc1
  buffer_load_dwordx4 v[36:39], v8, s[56:59], s30 offen offset:1024 sc1
  buffer_load_dwordx4 v[40:43], v8, s[56:59], s30 offen offset:2048 sc1
  buffer_load_dwordx4 v[44:47], v8, s[56:59], s30 offen offset:3072 sc1
  buffer_load_dwordx4 v[48:51], v8, s[56:59], s31 offen offset:0 sc1
  buffer_load_dwordx4 v[52:55], v8, s[56:59], s31 offen offset:1024 sc1
  buffer_load_dwordx4 v[56:59], v8, s[56:59], s31 offen offset:2048 sc1
  s_waitcnt vmcnt(0)
  v_mov_b32 v68, 0
  v_max3_u32 v68, v68, v32, v33
  v_max3_u32 v68, v68, v34, v35
  v_max3_u32 v68, v68, v36, v37
  v_max3_u32 v68, v68, v38, v39
  v_max3_u32 v68, v68, v40, v41
  v_max3_u32 v68, v68, v42, v43
  v_max3_u32 v68, v68, v44, v45
  v_max3_u32 v68, v68, v46, v47
  v_max3_u32 v68, v68, v48, v49
  v_max3_u32 v68, v68, v50, v51
  v_max3_u32 v68, v68, v52, v53
  v_max3_u32 v68, v68, v54, v55
  v_max3_u32 v68, v68, v56, v57
  v_max3_u32 v68, v68, v58, v59
  v_cmp_eq_u32 vcc, -1, v68
  s_cbranch_vccz H_SAFE_OK
  s_add_u32 s12, s12, 1
  s_cmp_gt_u32 s12, 20000
  s_cbranch_scc1 H_SAFE_OK
  s_sleep 2
  s_branch H_SAFE_SW
H_SAFE_OK:
  v_and_b32 v24, 4, v1
  v_cmp_eq_u32 vcc, 0, v24
  s_nop 0
  s_mov_b64 s[62:63], vcc
  v_mov_b32 v69, v35
  v_mov_b32_dpp v69, v35 row_shl:4 row_mask:0xf bank_mask:0xf
  v_cndmask_b32 v72, v35, v69, s[62:63]
  v_mov_b32 v69, v39
  v_mov_b32_dpp v69, v39 row_shl:4 row_mask:0xf bank_mask:0xf
  v_cndmask_b32 v73, v39, v69, s[62:63]
  v_mov_b32 v69, v43
  v_mov_b32_dpp v69, v43 row_shl:4 row_mask:0xf bank_mask:0xf
  v_cndmask_b32 v74, v43, v69, s[62:63]
  v_mov_b32 v69, v47
  v_mov_b32_dpp v69, v47 row_shl:4 row_mask:0xf bank_mask:0xf
  v_cndmask_b32 v75, v47, v69, s[62:63]
  v_mov_b32 v69, v51
  v_mov_b32_dpp v69, v51 row_shl:4 row_mask:0xf bank_mask:0xf
  v_cndmask_b32 v76, v51, v69, s[62:63]
  v_mov_b32 v69, v55
  v_mov_b32_dpp v69, v55 row_shl:4 row_mask:0xf bank_mask:0xf
  v_cndmask_b32 v77, v55, v69, s[62:63]
  v_mov_b32 v69, v59
  v_mov_b32_dpp v69, v59 row_shl:4 row_mask:0xf bank_mask:0xf
  v_cndmask_b32 v78, v59, v69, s[62:63]
  v_max3_f32 v80, v72, v73, v74
  v_max3_f32 v80, v80, v75, v76
  v_max3_f32 v80, v80, v77, v78
  v_mov_b32 v81, v80
  s_nop 1
  v_permlane16_swap_b32 v80, v81
  v_max_f32 v80, v80, v81
  v_mov_b32 v81, v80
  s_nop 1
  v_permlane32_swap_b32 v80, v81
  v_max_f32 v80, v80, v81
  s_lshl_b32 s60, s3, 8
  s_add_u32 s60, s60, 57344
  v_lshl_add_u32 v24, v1, 2, s60
  ds_write_b32 v24, v80
  s_waitcnt lgkmcnt(0)
  s_barrier
  v_lshlrev_b32 v24, 2, v1
  ds_read_b32 v84, v24 offset:57344
  ds_read_b32 v85, v24 offset:57600
  ds_read_b32 v86, v24 offset:57856
  ds_read_b32 v87, v24 offset:58112
  ds_read_b32 v88, v24 offset:58368
  ds_read_b32 v89, v24 offset:58624
  ds_read_b32 v90, v24 offset:58880
  ds_read_b32 v91, v24 offset:59136
  s_waitcnt lgkmcnt(5)
  v_max3_f32 v80, v84, v85, v86
  s_waitcnt lgkmcnt(3)
  v_max3_f32 v80, v80, v87, v88
  s_waitcnt lgkmcnt(1)
  v_max3_f32 v80, v80, v89, v90
  s_waitcnt lgkmcnt(0)
  v_max_f32 v80, v80, v91
  v_sub_f32 v72, v72, v80
  v_exp_f32 v72, v72
  v_cndmask_b32 v35, 0, v35, s[62:63]
  v_lshlrev_b32 v69, 16, v32
  v_and_b32 v70, 0xffff0000, v32
  v_mul_f32 v69, v69, v72
  v_mul_f32 v70, v70, v72
  v_cvt_pk_bf16_f32 v32, v69, v70
  v_lshlrev_b32 v69, 16, v33
  v_and_b32 v70, 0xffff0000, v33
  v_mul_f32 v69, v69, v72
  v_mul_f32 v70, v70, v72
  v_cvt_pk_bf16_f32 v33, v69, v70
  v_lshlrev_b32 v69, 16, v34
  v_and_b32 v70, 0xffff0000, v34
  v_mul_f32 v69, v69, v72
  v_mul_f32 v70, v70, v72
  v_cvt_pk_bf16_f32 v34, v69, v70
  v_lshlrev_b32 v69, 16, v35
  v_and_b32 v70, 0xffff0000, v35
  v_mul_f32 v69, v69, v72
  v_mul_f32 v70, v70, v72
  v_cvt_pk_bf16_f32 v35, v69, v70
  s_nop 1
  v_mfma_f32_16x16x32_bf16 v[60:63], v[64:67], v[32:35], v[60:63]
  v_sub_f32 v73, v73, v80
  v_exp_f32 v73, v73
  v_cndmask_b32 v39, 0, v39, s[62:63]
  v_lshlrev_b32 v69, 16, v36
  v_and_b32 v70, 0xffff0000, v36
  v_mul_f32 v69, v69, v73
  v_mul_f32 v70, v70, v73
  v_cvt_pk_bf16_f32 v36, v69, v70
  v_lshlrev_b32 v69, 16, v37
  v_and_b32 v70, 0xffff0000, v37
  v_mul_f32 v69, v69, v73
  v_mul_f32 v70, v70, v73
  v_cvt_pk_bf16_f32 v37, v69, v70
  v_lshlrev_b32 v69, 16, v38
  v_and_b32 v70, 0xffff0000, v38
  v_mul_f32 v69, v69, v73
  v_mul_f32 v70, v70, v73
  v_cvt_pk_bf16_f32 v38, v69, v70
  v_lshlrev_b32 v69, 16, v39
  v_and_b32 v70, 0xffff0000, v39
  v_mul_f32 v69, v69, v73
  v_mul_f32 v70, v70, v73
  v_cvt_pk_bf16_f32 v39, v69, v70
  s_nop 1
  v_mfma_f32_16x16x32_bf16 v[60:63], v[64:67], v[36:39], v[60:63]
  v_sub_f32 v74, v74, v80
  v_exp_f32 v74, v74
  v_cndmask_b32 v43, 0, v43, s[62:63]
  v_lshlrev_b32 v69, 16, v40
  v_and_b32 v70, 0xffff0000, v40
  v_mul_f32 v69, v69, v74
  v_mul_f32 v70, v70, v74
  v_cvt_pk_bf16_f32 v40, v69, v70
  v_lshlrev_b32 v69, 16, v41
  v_and_b32 v70, 0xffff0000, v41
  v_mul_f32 v69, v69, v74
  v_mul_f32 v70, v70, v74
  v_cvt_pk_bf16_f32 v41, v69, v70
  v_lshlrev_b32 v69, 16, v42
  v_and_b32 v70, 0xffff0000, v42
  v_mul_f32 v69, v69, v74
  v_mul_f32 v70, v70, v74
  v_cvt_pk_bf16_f32 v42, v69, v70
  v_lshlrev_b32 v69, 16, v43
  v_and_b32 v70, 0xffff0000, v43
  v_mul_f32 v69, v69, v74
  v_mul_f32 v70, v70, v74
  v_cvt_pk_bf16_f32 v43, v69, v70
  s_nop 1
  v_mfma_f32_16x16x32_bf16 v[60:63], v[64:67], v[40:43], v[60:63]
  v_sub_f32 v75, v75, v80
  v_exp_f32 v75, v75
  v_cndmask_b32 v47, 0, v47, s[62:63]
  v_lshlrev_b32 v69, 16, v44
  v_and_b32 v70, 0xffff0000, v44
  v_mul_f32 v69, v69, v75
  v_mul_f32 v70, v70, v75
  v_cvt_pk_bf16_f32 v44, v69, v70
  v_lshlrev_b32 v69, 16, v45
  v_and_b32 v70, 0xffff0000, v45
  v_mul_f32 v69, v69, v75
  v_mul_f32 v70, v70, v75
  v_cvt_pk_bf16_f32 v45, v69, v70
  v_lshlrev_b32 v69, 16, v46
  v_and_b32 v70, 0xffff0000, v46
  v_mul_f32 v69, v69, v75
  v_mul_f32 v70, v70, v75
  v_cvt_pk_bf16_f32 v46, v69, v70
  v_lshlrev_b32 v69, 16, v47
  v_and_b32 v70, 0xffff0000, v47
  v_mul_f32 v69, v69, v75
  v_mul_f32 v70, v70, v75
  v_cvt_pk_bf16_f32 v47, v69, v70
  s_nop 1
  v_mfma_f32_16x16x32_bf16 v[60:63], v[64:67], v[44:47], v[60:63]
  v_sub_f32 v76, v76, v80
  v_exp_f32 v76, v76
  v_cndmask_b32 v51, 0, v51, s[62:63]
  v_lshlrev_b32 v69, 16, v48
  v_and_b32 v70, 0xffff0000, v48
  v_mul_f32 v69, v69, v76
  v_mul_f32 v70, v70, v76
  v_cvt_pk_bf16_f32 v48, v69, v70
  v_lshlrev_b32 v69, 16, v49
  v_and_b32 v70, 0xffff0000, v49
  v_mul_f32 v69, v69, v76
  v_mul_f32 v70, v70, v76
  v_cvt_pk_bf16_f32 v49, v69, v70
  v_lshlrev_b32 v69, 16, v50
  v_and_b32 v70, 0xffff0000, v50
  v_mul_f32 v69, v69, v76
  v_mul_f32 v70, v70, v76
  v_cvt_pk_bf16_f32 v50, v69, v70
  v_lshlrev_b32 v69, 16, v51
  v_and_b32 v70, 0xffff0000, v51
  v_mul_f32 v69, v69, v76
  v_mul_f32 v70, v70, v76
  v_cvt_pk_bf16_f32 v51, v69, v70
  s_nop 1
  v_mfma_f32_16x16x32_bf16 v[60:63], v[64:67], v[48:51], v[60:63]
  v_sub_f32 v77, v77, v80
  v_exp_f32 v77, v77
  v_cndmask_b32 v55, 0, v55, s[62:63]
  v_lshlrev_b32 v69, 16, v52
  v_and_b32 v70, 0xffff0000, v52
  v_mul_f32 v69, v69, v77
  v_mul_f32 v70, v70, v77
  v_cvt_pk_bf16_f32 v52, v69, v70
  v_lshlrev_b32 v69, 16, v53
  v_and_b32 v70, 0xffff0000, v53
  v_mul_f32 v69, v69, v77
  v_mul_f32 v70, v70, v77
  v_cvt_pk_bf16_f32 v53, v69, v70
  v_lshlrev_b32 v69, 16, v54
  v_and_b32 v70, 0xffff0000, v54
  v_mul_f32 v69, v69, v77
  v_mul_f32 v70, v70, v77
  v_cvt_pk_bf16_f32 v54, v69, v70
  v_lshlrev_b32 v69, 16, v55
  v_and_b32 v70, 0xffff0000, v55
  v_mul_f32 v69, v69, v77
  v_mul_f32 v70, v70, v77
  v_cvt_pk_bf16_f32 v55, v69, v70
  s_nop 1
  v_mfma_f32_16x16x32_bf16 v[60:63], v[64:67], v[52:55], v[60:63]
  v_sub_f32 v78, v78, v80
  v_exp_f32 v78, v78
  v_cndmask_b32 v59, 0, v59, s[62:63]
  v_lshlrev_b32 v69, 16, v56
  v_and_b32 v70, 0xffff0000, v56
  v_mul_f32 v69, v69, v78
  v_mul_f32 v70, v70, v78
  v_cvt_pk_bf16_f32 v56, v69, v70
  v_lshlrev_b32 v69, 16, v57
  v_and_b32 v70, 0xffff0000, v57
  v_mul_f32 v69, v69, v78
  v_mul_f32 v70, v70, v78
  v_cvt_pk_bf16_f32 v57, v69, v70
  v_lshlrev_b32 v69, 16, v58
  v_and_b32 v70, 0xffff0000, v58
  v_mul_f32 v69, v69, v78
  v_mul_f32 v70, v70, v78
  v_cvt_pk_bf16_f32 v58, v69, v70
  v_lshlrev_b32 v69, 16, v59
  v_and_b32 v70, 0xffff0000, v59
  v_mul_f32 v69, v69, v78
  v_mul_f32 v70, v70, v78
  v_cvt_pk_bf16_f32 v59, v69, v70
  s_nop 1
  v_mfma_f32_16x16x32_bf16 v[60:63], v[64:67], v[56:59], v[60:63]
  s_branch H_SWEPT
H_END:
  s_mov_b64 exec, -1
  s_endpgm
MAINROLE:
  s_sub_u32 s15, s2, 32
  s_lshr_b32 s60, s15, 1
  s_and_b32 s61, s15, 1
  s_mul_i32 s62, s60, 112
  s_mul_i32 s63, s61, 56
  s_add_u32 s62, s62, s63
  s_mul_i32 s8, s62, 384
  s_mul_i32 s62, s60, 448
  s_mul_i32 s63, s61, 112
  s_add_u32 s62, s62, s63
  s_mul_i32 s6, s62, 384
  s_mov_b32 s64, 0x3f80
  s_mov_b32 s65, 0x3f800000
  s_mov_b32 s7, 0x3baaaaab
  v_add_u32 v20, 0, v1
  v_mul_u32_u24 v21, 171, v20
  v_lshrrev_b32 v21, 12, v21
  v_mul_u32_u24 v22, 24, v21
  v_sub_u32 v22, v20, v22
  v_and_b32 v23, 6, v21
  v_xor_b32 v23, v22, v23
  v_and_b32 v24, 2, v21
  v_xor_b32 v22, v22, v24
  v_lshlrev_b32 v22, 4, v22
  v_mul_u32_u24 v21, 384, v21
  v_lshl_add_u32 v16, v23, 4, v21
  s_and_b32 s60, s3, 1
  s_lshl_b32 s60, s60, 6
  v_xor_b32 v24, s60, v22
  v_add_u32 v10, v21, v24
  v_add_u32 v20, 64, v1
  v_mul_u32_u24 v21, 171, v20
  v_lshrrev_b32 v21, 12, v21
  v_mul_u32_u24 v22, 24, v21
  v_sub_u32 v22, v20, v22
  v_and_b32 v23, 6, v21
  v_xor_b32 v23, v22, v23
  v_and_b32 v24, 2, v21
  v_xor_b32 v22, v22, v24
  v_lshlrev_b32 v22, 4, v22
  v_mul_u32_u24 v21, 384, v21
  v_lshl_add_u32 v17, v23, 4, v21
  s_and_b32 s60, s3, 1
  s_lshl_b32 s60, s60, 6
  v_xor_b32 v24, s60, v22
  v_add_u32 v11, v21, v24
  v_add_u32 v20, 128, v1
  v_mul_u32_u24 v21, 171, v20
  v_lshrrev_b32 v21, 12, v21
  v_mul_u32_u24 v22, 24, v21
  v_sub_u32 v22, v20, v22
  v_and_b32 v23, 6, v21
  v_xor_b32 v23, v22, v23
  v_and_b32 v24, 2, v21
  v_xor_b32 v22, v22, v24
  v_lshlrev_b32 v22, 4, v22
  v_mul_u32_u24 v21, 384, v21
  v_lshl_add_u32 v18, v23, 4, v21
  s_and_b32 s60, s3, 1
  s_lshl_b32 s60, s60, 6
  v_xor_b32 v24, s60, v22
  v_add_u32 v12, v21, v24
  v_mul_u32_u24 v19, 384, v7
  v_lshl_add_u32 v19, v6, 4, v19
  s_waitcnt lgkmcnt(0)
  s_mov_b32 s44, s20
  s_and_b32 s45, s21, 0xffff
  s_mov_b32 s46, 4816896
  s_mov_b32 s47, 0x20000
  s_mov_b32 s48, s22
  s_and_b32 s49, s23, 0xffff
  s_mov_b32 s50, 73728
  s_mov_b32 s51, 0x20000
  s_load_dword s13, s[38:39], 0
  s_mul_i32 s60, s3, 3072
  s_add_u32 s62, s60, s8
  s_add_u32 s61, s60, 122880
  s_mov_b32 m0, s61
  s_nop 0
  buffer_load_dwordx4 v16, s[44:47], s62 offen lds
  s_add_u32 s61, s60, 123904
  s_mov_b32 m0, s61
  s_nop 0
  buffer_load_dwordx4 v17, s[44:47], s62 offen lds
  s_add_u32 s61, s60, 124928
  s_mov_b32 m0, s61
  s_nop 0
  buffer_load_dwordx4 v18, s[44:47], s62 offen lds
  s_mul_i32 s33, s15, 171
  s_lshr_b32 s33, s33, 9
  s_mul_i32 s33, s33, 3
  s_sub_u32 s33, s15, s33
  s_mul_i32 s33, s33, 24576
  s_add_u32 s34, s33, 24576
  s_cmp_ge_u32 s34, 73728
  s_cselect_b32 s61, 73728, 0
  s_sub_u32 s34, s34, s61
  s_add_u32 s35, s34, 24576
  s_cmp_ge_u32 s35, 73728
  s_cselect_b32 s61, 73728, 0
  s_sub_u32 s35, s35, s61
  s_add_u32 s62, s60, s33
  s_add_u32 s61, s62, 0
  s_mov_b32 m0, s61
  s_nop 0
  buffer_load_dwordx4 v10, s[48:51], s62 offen lds
  s_add_u32 s61, s62, 1024
  s_mov_b32 m0, s61
  s_nop 0
  buffer_load_dwordx4 v11, s[48:51], s62 offen lds
  s_add_u32 s61, s62, 2048
  s_mov_b32 m0, s61
  s_nop 0
  buffer_load_dwordx4 v12, s[48:51], s62 offen lds
  s_add_u32 s62, s60, s34
  s_add_u32 s61, s62, 0
  s_mov_b32 m0, s61
  s_nop 0
  buffer_load_dwordx4 v10, s[48:51], s62 offen lds
  s_add_u32 s61, s62, 1024
  s_mov_b32 m0, s61
  s_nop 0
  buffer_load_dwordx4 v11, s[48:51], s62 offen lds
  s_add_u32 s61, s62, 2048
  s_mov_b32 m0, s61
  s_nop 0
  buffer_load_dwordx4 v12, s[48:51], s62 offen lds
  s_add_u32 s62, s60, s35
  s_add_u32 s61, s62, 0
  s_mov_b32 m0, s61
  s_nop 0
  buffer_load_dwordx4 v10, s[48:51], s62 offen lds
  s_add_u32 s61, s62, 1024
  s_mov_b32 m0, s61
  s_nop 0
  buffer_load_dwordx4 v11, s[48:51], s62 offen lds
  s_add_u32 s61, s62, 2048
  s_mov_b32 m0, s61
  s_nop 0
  buffer_load_dwordx4 v12, s[48:51], s62 offen lds
  s_mov_b32 s40, s18
  s_and_b32 s41, s19, 0xffff
  s_mov_b32 s42, 19267584
  s_mov_b32 s43, 0x20000
  s_mov_b32 s52, s28
  s_and_b32 s53, s29, 0xffff
  s_mov_b32 s54, 73728
  s_mov_b32 s55, 0x20000
  s_mov_b32 s56, s38
  s_and_b32 s57, s39, 0xffff
  s_mov_b32 s58, 33554432
  s_mov_b32 s59, 0x20000
  s_mul_i32 s9, s5, 86016
  s_mul_i32 s60, s4, 3072
  s_add_u32 s9, s9, s60
  s_add_u32 s9, s9, s6
  s_lshr_b32 s60, s3, 1
  s_mul_i32 s10, s60, 86016
  s_and_b32 s60, s3, 1
  s_mul_i32 s60, s60, 3072
  s_add_u32 s10, s10, s60
  s_add_u32 s10, s10, s6
  s_add_u32 s10, s10, 36864
  v_lshl_add_u32 v24, v3, 3, v5
  v_mul_u32_u24 v24, 384, v24
  v_and_b32 v25, 1, v4
  v_lshl_add_u32 v24, v25, 3, v24
  v_and_b32 v25, 2, v5
  v_and_b32 v26, 1, v3
  v_lshl_or_b32 v25, v26, 2, v25
  v_lshrrev_b32 v26, 1, v4
  v_xor_b32 v25, v25, v26
  v_mul_u32_u24 v27, 768, v2
  s_mul_i32 s60, s5, 24576
  s_add_u32 s60, s60, 73728
  v_add_u32 v27, s60, v27
  v_xor_b32 v26, v3, v2
  v_and_b32 v26, 1, v26
  v_lshl_add_u32 v27, v26, 7, v27
  v_lshrrev_b32 v26, 1, v3
  v_and_b32 v31, 7, v2
  v_xor_b32 v31, v31, v26
  s_mul_i32 s60, s4, 3
  s_add_u32 s61, s60, 0
  s_and_b32 s62, s61, 3
  s_lshl_b32 s62, s62, 1
  s_lshr_b32 s63, s61, 2
  v_xor_b32 v26, s62, v25
  v_lshl_add_u32 v20, v26, 4, v24
  s_lshl_b32 s61, s63, 7
  v_add_u32 v20, s61, v20
  v_xor_b32 v26, s62, v31
  v_lshl_add_u32 v28, v26, 4, v27
  s_lshl_b32 s61, s63, 8
  v_add_u32 v28, s61, v28
  s_add_u32 s61, s60, 1
  s_and_b32 s62, s61, 3
  s_lshl_b32 s62, s62, 1
  s_lshr_b32 s63, s61, 2
  v_xor_b32 v26, s62, v25
  v_lshl_add_u32 v21, v26, 4, v24
  s_lshl_b32 s61, s63, 7
  v_add_u32 v21, s61, v21
  v_xor_b32 v26, s62, v31
  v_lshl_add_u32 v29, v26, 4, v27
  s_lshl_b32 s61, s63, 8
  v_add_u32 v29, s61, v29
  s_add_u32 s61, s60, 2
  s_and_b32 s62, s61, 3
  s_lshl_b32 s62, s62, 1
  s_lshr_b32 s63, s61, 2
  v_xor_b32 v26, s62, v25
  v_lshl_add_u32 v22, v26, 4, v24
  s_lshl_b32 s61, s63, 7
  v_add_u32 v22, s61, v22
  v_xor_b32 v26, s62, v31
  v_lshl_add_u32 v30, v26, 4, v27
  s_lshl_b32 s61, s63, 8
  v_add_u32 v30, s61, v30
  v_mul_u32_u24 v25, 384, v2
  v_and_b32 v26, 6, v2
  v_xor_b32 v26, v26, v3
  v_lshl_add_u32 v8, v26, 4, v25
  v_xor_b32 v26, 4, v26
  v_lshl_add_u32 v9, v26, 4, v25
  s_mul_i32 s60, s5, 12288
  s_add_u32 s60, s60, 122880
  v_add_u32 v16, s60, v8
  v_add_u32 v17, s60, v9
  v_and_b32 v18, 31, v1
  v_lshlrev_b32 v18, 2, v18
  s_and_b32 s16, s15, 15
  s_lshl_b32 s16, s16, 7
  s_add_u32 s16, s16, 4096
  s_waitcnt vmcnt(6)
  s_barrier
  v_add_u32 v24, s33, v20
  v_add_u32 v25, s33, v21
  v_add_u32 v26, s33, v22
  s_mul_i32 s61, s33, 0x15556
  s_lshr_b32 s61, s33, 13
  s_mul_i32 s61, s61, 43
  s_and_b32 s61, s61, 0x180
  v_add_u32 v27, s61, v16
  v_add_u32 v15, s61, v17
  ds_read_b128 v[80:83], v27 offset:0
  ds_read_b64_tr_b16 v[56:57], v24 offset:0
  ds_read_b64_tr_b16 v[58:59], v24 offset:1536
  ds_read_b64_tr_b16 v[60:61], v25 offset:0
  ds_read_b64_tr_b16 v[62:63], v25 offset:1536
  ds_read_b64_tr_b16 v[64:65], v26 offset:0
  ds_read_b64_tr_b16 v[66:67], v26 offset:1536
  ds_read_b128 v[84:87], v27 offset:6144
  buffer_load_dwordx4 v[160:163], v19, s[40:43], s9 offen offset:0
  buffer_load_dwordx4 v[164:167], v19, s[40:43], s9 offen offset:128
  buffer_load_dwordx4 v[168:171], v19, s[40:43], s9 offen offset:256
  ds_read_b128 v[88:91], v15 offset:0
  s_waitcnt lgkmcnt(6)
  v_mfma_f32_16x16x32_bf16 v[32:35], v[56:59], v[80:83], 0
  ds_read_b64_tr_b16 v[68:69], v24 offset:12288
  s_waitcnt lgkmcnt(5)
  v_mfma_f32_16x16x32_bf16 v[36:39], v[60:63], v[80:83], 0
  ds_read_b64_tr_b16 v[70:71], v24 offset:13824
  s_waitcnt lgkmcnt(4)
  v_mfma_f32_16x16x32_bf16 v[40:43], v[64:67], v[80:83], 0
  ds_read_b64_tr_b16 v[72:73], v25 offset:12288
  ds_read_b64_tr_b16 v[74:75], v25 offset:13824
  s_waitcnt lgkmcnt(5)
  v_mfma_f32_16x16x32_bf16 v[44:47], v[56:59], v[84:87], 0
  ds_read_b64_tr_b16 v[76:77], v26 offset:12288
  v_mfma_f32_16x16x32_bf16 v[48:51], v[60:63], v[84:87], 0
  ds_read_b64_tr_b16 v[78:79], v26 offset:13824
  v_mfma_f32_16x16x32_bf16 v[52:55], v[64:67], v[84:87], 0
  ds_read_b128 v[92:95], v15 offset:6144
  s_waitcnt lgkmcnt(5)
  v_mfma_f32_16x16x32_bf16 v[32:35], v[68:71], v[88:91], v[32:35]
  s_waitcnt lgkmcnt(3)
  v_mfma_f32_16x16x32_bf16 v[36:39], v[72:75], v[88:91], v[36:39]
  s_waitcnt lgkmcnt(1)
  v_mfma_f32_16x16x32_bf16 v[40:43], v[76:79], v[88:91], v[40:43]
  s_waitcnt lgkmcnt(0)
  v_mfma_f32_16x16x32_bf16 v[44:47], v[68:71], v[92:95], v[44:47]
  v_mfma_f32_16x16x32_bf16 v[48:51], v[72:75], v[92:95], v[48:51]
  v_mfma_f32_16x16x32_bf16 v[52:55], v[76:79], v[92:95], v[52:55]
  s_waitcnt vmcnt(6)
  s_barrier
  v_add_u32 v24, s34, v20
  v_add_u32 v25, s34, v21
  v_add_u32 v26, s34, v22
  s_mul_i32 s61, s34, 0x15556
  s_lshr_b32 s61, s34, 13
  s_mul_i32 s61, s61, 43
  s_and_b32 s61, s61, 0x180
  v_add_u32 v27, s61, v16
  v_add_u32 v15, s61, v17
  ds_read_b128 v[80:83], v27 offset:0
  ds_read_b64_tr_b16 v[56:57], v24 offset:0
  ds_read_b64_tr_b16 v[58:59], v24 offset:1536
  ds_read_b64_tr_b16 v[60:61], v25 offset:0
  ds_read_b64_tr_b16 v[62:63], v25 offset:1536
  ds_read_b64_tr_b16 v[64:65], v26 offset:0
  ds_read_b64_tr_b16 v[66:67], v26 offset:1536
  ds_read_b128 v[84:87], v27 offset:6144
  s_add_u32 s61, s9, 12288
  buffer_load_dwordx4 v[172:175], v19, s[40:43], s61 offen offset:0
  buffer_load_dwordx4 v[176:179], v19, s[40:43], s61 offen offset:128
  buffer_load_dwordx4 v[180:183], v19, s[40:43], s61 offen offset:256
  ds_read_b128 v[88:91], v15 offset:0
  s_waitcnt lgkmcnt(6)
  v_mfma_f32_16x16x32_bf16 v[32:35], v[56:59], v[80:83], v[32:35]
  ds_read_b64_tr_b16 v[68:69], v24 offset:12288
  s_waitcnt lgkmcnt(5)
  v_mfma_f32_16x16x32_bf16 v[36:39], v[60:63], v[80:83], v[36:39]
  ds_read_b64_tr_b16 v[70:71], v24 offset:13824
  s_waitcnt lgkmcnt(4)
  v_mfma_f32_16x16x32_bf16 v[40:43], v[64:67], v[80:83], v[40:43]
  ds_read_b64_tr_b16 v[72:73], v25 offset:12288
  ds_read_b64_tr_b16 v[74:75], v25 offset:13824
  s_waitcnt lgkmcnt(5)
  v_mfma_f32_16x16x32_bf16 v[44:47], v[56:59], v[84:87], v[44:47]
  ds_read_b64_tr_b16 v[76:77], v26 offset:12288
  v_mfma_f32_16x16x32_bf16 v[48:51], v[60:63], v[84:87], v[48:51]
  ds_read_b64_tr_b16 v[78:79], v26 offset:13824
  v_mfma_f32_16x16x32_bf16 v[52:55], v[64:67], v[84:87], v[52:55]
  ds_read_b128 v[92:95], v15 offset:6144
  s_waitcnt lgkmcnt(5)
  v_mfma_f32_16x16x32_bf16 v[32:35], v[68:71], v[88:91], v[32:35]
  s_waitcnt lgkmcnt(3)
  v_mfma_f32_16x16x32_bf16 v[36:39], v[72:75], v[88:91], v[36:39]
  s_waitcnt lgkmcnt(1)
  v_mfma_f32_16x16x32_bf16 v[40:43], v[76:79], v[88:91], v[40:43]
  s_waitcnt lgkmcnt(0)
  v_mfma_f32_16x16x32_bf16 v[44:47], v[68:71], v[92:95], v[44:47]
  v_mfma_f32_16x16x32_bf16 v[48:51], v[72:75], v[92:95], v[48:51]
  v_mfma_f32_16x16x32_bf16 v[52:55], v[76:79], v[92:95], v[52:55]
  s_waitcnt vmcnt(6)
  s_barrier
  v_add_u32 v24, s35, v20
  v_add_u32 v25, s35, v21
  v_add_u32 v26, s35, v22
  s_mul_i32 s61, s35, 0x15556
  s_lshr_b32 s61, s35, 13
  s_mul_i32 s61, s61, 43
  s_and_b32 s61, s61, 0x180
  v_add_u32 v27, s61, v16
  v_add_u32 v15, s61, v17
  ds_read_b128 v[80:83], v27 offset:0
  ds_read_b64_tr_b16 v[56:57], v24 offset:0
  ds_read_b64_tr_b16 v[58:59], v24 offset:1536
  ds_read_b64_tr_b16 v[60:61], v25 offset:0
  ds_read_b64_tr_b16 v[62:63], v25 offset:1536
  ds_read_b64_tr_b16 v[64:65], v26 offset:0
  ds_read_b64_tr_b16 v[66:67], v26 offset:1536
  ds_read_b128 v[84:87], v27 offset:6144
  ds_read_b128 v[88:91], v15 offset:0
  s_waitcnt lgkmcnt(6)
  v_mfma_f32_16x16x32_bf16 v[32:35], v[56:59], v[80:83], v[32:35]
  ds_read_b64_tr_b16 v[68:69], v24 offset:12288
  s_waitcnt lgkmcnt(5)
  v_mfma_f32_16x16x32_bf16 v[36:39], v[60:63], v[80:83], v[36:39]
  ds_read_b64_tr_b16 v[70:71], v24 offset:13824
  s_waitcnt lgkmcnt(4)
  v_mfma_f32_16x16x32_bf16 v[40:43], v[64:67], v[80:83], v[40:43]
  ds_read_b64_tr_b16 v[72:73], v25 offset:12288
  ds_read_b64_tr_b16 v[74:75], v25 offset:13824
  s_waitcnt lgkmcnt(5)
  v_mfma_f32_16x16x32_bf16 v[44:47], v[56:59], v[84:87], v[44:47]
  ds_read_b64_tr_b16 v[76:77], v26 offset:12288
  v_mfma_f32_16x16x32_bf16 v[48:51], v[60:63], v[84:87], v[48:51]
  ds_read_b64_tr_b16 v[78:79], v26 offset:13824
  v_mfma_f32_16x16x32_bf16 v[52:55], v[64:67], v[84:87], v[52:55]
  ds_read_b128 v[92:95], v15 offset:6144
  s_waitcnt lgkmcnt(5)
  v_mfma_f32_16x16x32_bf16 v[32:35], v[68:71], v[88:91], v[32:35]
  s_waitcnt lgkmcnt(3)
  v_mfma_f32_16x16x32_bf16 v[36:39], v[72:75], v[88:91], v[36:39]
  s_waitcnt lgkmcnt(1)
  v_mfma_f32_16x16x32_bf16 v[40:43], v[76:79], v[88:91], v[40:43]
  s_waitcnt lgkmcnt(0)
  v_mfma_f32_16x16x32_bf16 v[44:47], v[68:71], v[92:95], v[44:47]
  v_mfma_f32_16x16x32_bf16 v[48:51], v[72:75], v[92:95], v[48:51]
  v_mfma_f32_16x16x32_bf16 v[52:55], v[76:79], v[92:95], v[52:55]
  ds_write_b128 v28, v[32:35] offset:0
  s_nop 0
  ds_write_b128 v29, v[36:39] offset:0
  s_nop 0
  ds_write_b128 v30, v[40:43] offset:0
  s_nop 0
  ds_write_b128 v28, v[44:47] offset:12288
  ds_write_b128 v29, v[48:51] offset:12288
  ds_write_b128 v30, v[52:55] offset:12288
  v_mul_u32_u24 v24, 768, v3
  s_and_b32 s60, s3, 1
  s_lshl_b32 s60, s60, 2
  v_or_b32 v25, s60, v3
  v_xor_b32 v25, v25, v6
  v_lshl_add_u32 v24, v25, 4, v24
  v_and_b32 v25, 1, v3
  v_lshl_add_u32 v10, v25, 7, v24
  v_xor_b32 v25, 1, v25
  v_lshl_add_u32 v11, v25, 7, v24
  s_lshl_b32 s60, s4, 3
  v_add_u32 v24, s60, v7
  v_mul_u32_u24 v24, 384, v24
  v_and_b32 v25, 6, v7
  v_xor_b32 v25, v25, v6
  v_lshl_add_u32 v12, v25, 4, v24
  v_lshl_add_u32 v25, v3, 2, v5
  v_and_b32 v26, 6, v25
  v_mul_u32_u24 v27, 384, v25
  v_and_b32 v14, 1, v4
  v_lshl_add_u32 v27, v14, 3, v27
  v_lshrrev_b32 v14, 1, v4
  v_xor_b32 v26, v26, v14
  v_xor_b32 v14, 0, v26
  v_lshl_add_u32 v20, v14, 4, v27
  v_xor_b32 v14, 2, v26
  v_lshl_add_u32 v21, v14, 4, v27
  v_xor_b32 v14, 4, v26
  v_lshl_add_u32 v22, v14, 4, v27
  v_xor_b32 v14, 6, v26
  v_lshl_add_u32 v23, v14, 4, v27
  v_mul_u32_u24 v14, 96, v25
  v_lshl_add_u32 v14, v4, 3, v14
  s_mul_i32 s61, s4, 18432
  v_add_u32 v14, s61, v14
  v_mov_b32 v148, 0x3f803f80
  v_mov_b32 v149, 0x3f803f80
  v_mov_b32 v150, 0x3f803f80
  v_mov_b32 v151, 0x3f803f80
  v_lshlrev_b32 v31, 4, v1
  s_waitcnt lgkmcnt(0)
  s_mul_i32 s14, s13, 0x9E3779B1
  s_add_u32 s14, s14, 0x7F4A7C15
  s_barrier
  s_mul_i32 s11, s4, 18432
  s_mul_i32 s60, s5, 9216
  s_add_u32 s11, s11, s60
  s_lshl_b32 s60, s3, 12
  s_add_u32 s60, s60, 0
  s_add_u32 s61, s60, 0
  s_mov_b32 m0, s61
  s_add_u32 s60, s60, 8192
  buffer_load_dwordx4 v31, s[56:59], s60 offen sc1 lds
  s_lshl_b32 s60, s3, 12
  s_add_u32 s60, s60, 1024
  s_add_u32 s61, s60, 0
  s_mov_b32 m0, s61
  s_add_u32 s60, s60, 8192
  buffer_load_dwordx4 v31, s[56:59], s60 offen sc1 lds
  s_cmp_eq_u32 s3, 7
  s_cbranch_scc1 AFS_17
  s_lshl_b32 s60, s3, 12
  s_add_u32 s60, s60, 2048
  s_add_u32 s61, s60, 0
  s_mov_b32 m0, s61
  s_add_u32 s60, s60, 8192
  buffer_load_dwordx4 v31, s[56:59], s60 offen sc1 lds
AFS_17:
  s_cmp_eq_u32 s3, 7
  s_cbranch_scc1 AFS_18
  s_lshl_b32 s60, s3, 12
  s_add_u32 s60, s60, 3072
  s_add_u32 s61, s60, 0
  s_mov_b32 m0, s61
  s_add_u32 s60, s60, 8192
  buffer_load_dwordx4 v31, s[56:59], s60 offen sc1 lds
AFS_18:
  s_mul_i32 s60, s4, 3072
  s_add_u32 s60, s60, 73728
  v_add_u32 v13, s60, v10
  v_add_u32 v15, s60, v11
  ds_read_b128 v[64:67], v13 offset:0
  ds_read_b128 v[68:71], v15 offset:0
  ds_read_b128 v[72:75], v13 offset:256
  ds_read_b128 v[76:79], v15 offset:256
  ds_read_b128 v[80:83], v13 offset:512
  ds_read_b128 v[84:87], v15 offset:512
  s_cmp_eq_u32 s5, 0
  s_mov_b32 s12, 122880
  s_cselect_b32 s12, s12, 135168
  v_add_u32 v26, s12, v12
  s_waitcnt vmcnt(7) lgkmcnt(5)
  v_dot2_f32_bf16 v32, v160, s64, v64
  v_dot2_f32_bf16 v33, v160, s65, v65
  v_dot2_f32_bf16 v34, v161, s64, v66
  v_dot2_f32_bf16 v35, v161, s65, v67
  v_pk_mul_f32 v[92:93], v[32:33], v[32:33]
  s_waitcnt lgkmcnt(4)
  v_dot2_f32_bf16 v36, v162, s64, v68
  v_dot2_f32_bf16 v37, v162, s65, v69
  v_pk_add_f32 v[94:95], v[32:33], v[34:35]
  v_pk_fma_f32 v[92:93], v[34:35], v[34:35], v[92:93]
  v_dot2_f32_bf16 v38, v163, s64, v70
  v_dot2_f32_bf16 v39, v163, s65, v71
  v_pk_add_f32 v[94:95], v[94:95], v[36:37]
  v_pk_fma_f32 v[92:93], v[36:37], v[36:37], v[92:93]
  s_waitcnt vmcnt(6) lgkmcnt(3)
  v_dot2_f32_bf16 v40, v164, s64, v72
  v_dot2_f32_bf16 v41, v164, s65, v73
  v_pk_add_f32 v[94:95], v[94:95], v[38:39]
  v_pk_fma_f32 v[92:93], v[38:39], v[38:39], v[92:93]
  v_dot2_f32_bf16 v42, v165, s64, v74
  v_dot2_f32_bf16 v43, v165, s65, v75
  v_pk_add_f32 v[94:95], v[94:95], v[40:41]
  v_pk_fma_f32 v[92:93], v[40:41], v[40:41], v[92:93]
  s_waitcnt lgkmcnt(2)
  v_dot2_f32_bf16 v44, v166, s64, v76
  v_dot2_f32_bf16 v45, v166, s65, v77
  v_pk_add_f32 v[94:95], v[94:95], v[42:43]
  v_pk_fma_f32 v[92:93], v[42:43], v[42:43], v[92:93]
  v_dot2_f32_bf16 v46, v167, s64, v78
  v_dot2_f32_bf16 v47, v167, s65, v79
  v_pk_add_f32 v[94:95], v[94:95], v[44:45]
  v_pk_fma_f32 v[92:93], v[44:45], v[44:45], v[92:93]
  s_waitcnt vmcnt(5) lgkmcnt(1)
  v_dot2_f32_bf16 v48, v168, s64, v80
  v_dot2_f32_bf16 v49, v168, s65, v81
  v_pk_add_f32 v[94:95], v[94:95], v[46:47]
  v_pk_fma_f32 v[92:93], v[46:47], v[46:47], v[92:93]
  v_dot2_f32_bf16 v50, v169, s64, v82
  v_dot2_f32_bf16 v51, v169, s65, v83
  v_pk_add_f32 v[94:95], v[94:95], v[48:49]
  v_pk_fma_f32 v[92:93], v[48:49], v[48:49], v[92:93]
  s_waitcnt lgkmcnt(0)
  v_dot2_f32_bf16 v52, v170, s64, v84
  v_dot2_f32_bf16 v53, v170, s65, v85
  v_pk_add_f32 v[94:95], v[94:95], v[50:51]
  v_pk_fma_f32 v[92:93], v[50:51], v[50:51], v[92:93]
  v_dot2_f32_bf16 v54, v171, s64, v86
  v_dot2_f32_bf16 v55, v171, s65, v87
  v_pk_add_f32 v[94:95], v[94:95], v[52:53]
  v_pk_fma_f32 v[92:93], v[52:53], v[52:53], v[92:93]
  v_pk_add_f32 v[94:95], v[94:95], v[54:55]
  v_pk_fma_f32 v[92:93], v[54:55], v[54:55], v[92:93]
  v_add_f32 v94, v94, v95
  v_add_f32 v92, v92, v93
  s_nop 0
  v_add_f32_dpp v94, v94, v94 quad_perm:[1,0,3,2] row_mask:0xf bank_mask:0xf
  v_add_f32_dpp v92, v92, v92 quad_perm:[1,0,3,2] row_mask:0xf bank_mask:0xf
  s_nop 0
  v_add_f32_dpp v94, v94, v94 quad_perm:[2,3,0,1] row_mask:0xf bank_mask:0xf
  v_add_f32_dpp v92, v92, v92 quad_perm:[2,3,0,1] row_mask:0xf bank_mask:0xf
  s_nop 0
  v_add_f32_dpp v94, v94, v94 row_half_mirror row_mask:0xf bank_mask:0xf
  v_add_f32_dpp v92, v92, v92 row_half_mirror row_mask:0xf bank_mask:0xf
  v_mul_f32 v94, s7, v94
  v_mul_f32 v95, v94, v94
  v_fma_f32 v92, v92, s7, -v95
  v_add_f32 v92, 0x3727c5ac, v92
  v_rsq_f32 v28, v92
  s_nop 0
  v_mul_f32 v30, -v94, v28
  v_pk_fma_f32 v[32:33], v[32:33], v[28:29], v[30:31] op_sel_hi:[1,0,0]
  v_pk_fma_f32 v[34:35], v[34:35], v[28:29], v[30:31] op_sel_hi:[1,0,0]
  v_pk_fma_f32 v[36:37], v[36:37], v[28:29], v[30:31] op_sel_hi:[1,0,0]
  v_pk_fma_f32 v[38:39], v[38:39], v[28:29], v[30:31] op_sel_hi:[1,0,0]
  v_cvt_pk_bf16_f32 v64, v32, v33
  v_cvt_pk_bf16_f32 v65, v34, v35
  v_cvt_pk_bf16_f32 v66, v36, v37
  v_cvt_pk_bf16_f32 v67, v38, v39
  ds_write_b128 v26, v[64:67] offset:0
  v_pk_fma_f32 v[40:41], v[40:41], v[28:29], v[30:31] op_sel_hi:[1,0,0]
  v_pk_fma_f32 v[42:43], v[42:43], v[28:29], v[30:31] op_sel_hi:[1,0,0]
  v_pk_fma_f32 v[44:45], v[44:45], v[28:29], v[30:31] op_sel_hi:[1,0,0]
  v_pk_fma_f32 v[46:47], v[46:47], v[28:29], v[30:31] op_sel_hi:[1,0,0]
  v_cvt_pk_bf16_f32 v68, v40, v41
  v_cvt_pk_bf16_f32 v69, v42, v43
  v_cvt_pk_bf16_f32 v70, v44, v45
  v_cvt_pk_bf16_f32 v71, v46, v47
  ds_write_b128 v26, v[68:71] offset:128
  v_pk_fma_f32 v[48:49], v[48:49], v[28:29], v[30:31] op_sel_hi:[1,0,0]
  v_pk_fma_f32 v[50:51], v[50:51], v[28:29], v[30:31] op_sel_hi:[1,0,0]
  v_pk_fma_f32 v[52:53], v[52:53], v[28:29], v[30:31] op_sel_hi:[1,0,0]
  v_pk_fma_f32 v[54:55], v[54:55], v[28:29], v[30:31] op_sel_hi:[1,0,0]
  v_cvt_pk_bf16_f32 v72, v48, v49
  v_cvt_pk_bf16_f32 v73, v50, v51
  v_cvt_pk_bf16_f32 v74, v52, v53
  v_cvt_pk_bf16_f32 v75, v54, v55
  ds_write_b128 v26, v[72:75] offset:256
  s_mul_i32 s60, s4, 3072
  s_add_u32 s60, s60, 86016
  v_add_u32 v13, s60, v10
  v_add_u32 v15, s60, v11
  ds_read_b128 v[64:67], v13 offset:0
  ds_read_b128 v[68:71], v15 offset:0
  ds_read_b128 v[72:75], v13 offset:256
  ds_read_b128 v[76:79], v15 offset:256
  ds_read_b128 v[80:83], v13 offset:512
  ds_read_b128 v[84:87], v15 offset:512
  s_add_u32 s61, s9, 24576
  buffer_load_dwordx4 v[184:187], v19, s[40:43], s61 offen offset:0
  buffer_load_dwordx4 v[188:191], v19, s[40:43], s61 offen offset:128
  buffer_load_dwordx4 v[192:195], v19, s[40:43], s61 offen offset:256
  s_waitcnt lgkmcnt(6)
  s_barrier
  s_cmp_eq_u32 s5, 0
  s_mov_b32 s12, 73728
  s_cselect_b32 s12, s12, 147456
  v_add_u32 v26, s12, v12
  s_waitcnt vmcnt(7) lgkmcnt(5)
  v_dot2_f32_bf16 v32, v172, s64, v64
  v_dot2_f32_bf16 v33, v172, s65, v65
  v_dot2_f32_bf16 v34, v173, s64, v66
  v_dot2_f32_bf16 v35, v173, s65, v67
  v_pk_mul_f32 v[92:93], v[32:33], v[32:33]
  s_waitcnt lgkmcnt(4)
  v_dot2_f32_bf16 v36, v174, s64, v68
  v_dot2_f32_bf16 v37, v174, s65, v69
  v_pk_add_f32 v[94:95], v[32:33], v[34:35]
  v_pk_fma_f32 v[92:93], v[34:35], v[34:35], v[92:93]
  v_dot2_f32_bf16 v38, v175, s64, v70
  v_dot2_f32_bf16 v39, v175, s65, v71
  v_pk_add_f32 v[94:95], v[94:95], v[36:37]
  v_pk_fma_f32 v[92:93], v[36:37], v[36:37], v[92:93]
  s_waitcnt vmcnt(6) lgkmcnt(3)
  v_dot2_f32_bf16 v40, v176, s64, v72
  v_dot2_f32_bf16 v41, v176, s65, v73
  v_pk_add_f32 v[94:95], v[94:95], v[38:39]
  v_pk_fma_f32 v[92:93], v[38:39], v[38:39], v[92:93]
  v_dot2_f32_bf16 v42, v177, s64, v74
  v_dot2_f32_bf16 v43, v177, s65, v75
  v_pk_add_f32 v[94:95], v[94:95], v[40:41]
  v_pk_fma_f32 v[92:93], v[40:41], v[40:41], v[92:93]
  s_waitcnt lgkmcnt(2)
  v_dot2_f32_bf16 v44, v178, s64, v76
  v_dot2_f32_bf16 v45, v178, s65, v77
  v_pk_add_f32 v[94:95], v[94:95], v[42:43]
  v_pk_fma_f32 v[92:93], v[42:43], v[42:43], v[92:93]
  v_dot2_f32_bf16 v46, v179, s64, v78
  v_dot2_f32_bf16 v47, v179, s65, v79
  v_pk_add_f32 v[94:95], v[94:95], v[44:45]
  v_pk_fma_f32 v[92:93], v[44:45], v[44:45], v[92:93]
  s_waitcnt vmcnt(5) lgkmcnt(1)
  v_dot2_f32_bf16 v48, v180, s64, v80
  v_dot2_f32_bf16 v49, v180, s65, v81
  v_pk_add_f32 v[94:95], v[94:95], v[46:47]
  v_pk_fma_f32 v[92:93], v[46:47], v[46:47], v[92:93]
  v_dot2_f32_bf16 v50, v181, s64, v82
  v_dot2_f32_bf16 v51, v181, s65, v83
  v_pk_add_f32 v[94:95], v[94:95], v[48:49]
  v_pk_fma_f32 v[92:93], v[48:49], v[48:49], v[92:93]
  s_waitcnt lgkmcnt(0)
  v_dot2_f32_bf16 v52, v182, s64, v84
  v_dot2_f32_bf16 v53, v182, s65, v85
  v_pk_add_f32 v[94:95], v[94:95], v[50:51]
  v_pk_fma_f32 v[92:93], v[50:51], v[50:51], v[92:93]
  v_dot2_f32_bf16 v54, v183, s64, v86
  v_dot2_f32_bf16 v55, v183, s65, v87
  v_pk_add_f32 v[94:95], v[94:95], v[52:53]
  v_pk_fma_f32 v[92:93], v[52:53], v[52:53], v[92:93]
  v_pk_add_f32 v[94:95], v[94:95], v[54:55]
  v_pk_fma_f32 v[92:93], v[54:55], v[54:55], v[92:93]
  v_add_f32 v94, v94, v95
  v_add_f32 v92, v92, v93
  s_nop 0
  v_add_f32_dpp v94, v94, v94 quad_perm:[1,0,3,2] row_mask:0xf bank_mask:0xf
  v_add_f32_dpp v92, v92, v92 quad_perm:[1,0,3,2] row_mask:0xf bank_mask:0xf
  s_nop 0
  v_add_f32_dpp v94, v94, v94 quad_perm:[2,3,0,1] row_mask:0xf bank_mask:0xf
  v_add_f32_dpp v92, v92, v92 quad_perm:[2,3,0,1] row_mask:0xf bank_mask:0xf
  s_nop 0
  v_add_f32_dpp v94, v94, v94 row_half_mirror row_mask:0xf bank_mask:0xf
  v_add_f32_dpp v92, v92, v92 row_half_mirror row_mask:0xf bank_mask:0xf
  v_mul_f32 v94, s7, v94
  v_mul_f32 v95, v94, v94
  v_fma_f32 v92, v92, s7, -v95
  v_add_f32 v92, 0x3727c5ac, v92
  v_rsq_f32 v28, v92
  s_nop 0
  v_mul_f32 v30, -v94, v28
  v_pk_fma_f32 v[32:33], v[32:33], v[28:29], v[30:31] op_sel_hi:[1,0,0]
  v_pk_fma_f32 v[34:35], v[34:35], v[28:29], v[30:31] op_sel_hi:[1,0,0]
  v_pk_fma_f32 v[36:37], v[36:37], v[28:29], v[30:31] op_sel_hi:[1,0,0]
  v_pk_fma_f32 v[38:39], v[38:39], v[28:29], v[30:31] op_sel_hi:[1,0,0]
  v_cvt_pk_bf16_f32 v64, v32, v33
  v_cvt_pk_bf16_f32 v65, v34, v35
  v_cvt_pk_bf16_f32 v66, v36, v37
  v_cvt_pk_bf16_f32 v67, v38, v39
  ds_write_b128 v26, v[64:67] offset:0
  v_pk_fma_f32 v[40:41], v[40:41], v[28:29], v[30:31] op_sel_hi:[1,0,0]
  v_pk_fma_f32 v[42:43], v[42:43], v[28:29], v[30:31] op_sel_hi:[1,0,0]
  v_pk_fma_f32 v[44:45], v[44:45], v[28:29], v[30:31] op_sel_hi:[1,0,0]
  v_pk_fma_f32 v[46:47], v[46:47], v[28:29], v[30:31] op_sel_hi:[1,0,0]
  v_cvt_pk_bf16_f32 v68, v40, v41
  v_cvt_pk_bf16_f32 v69, v42, v43
  v_cvt_pk_bf16_f32 v70, v44, v45
  v_cvt_pk_bf16_f32 v71, v46, v47
  ds_write_b128 v26, v[68:71] offset:128
  v_pk_fma_f32 v[48:49], v[48:49], v[28:29], v[30:31] op_sel_hi:[1,0,0]
  v_pk_fma_f32 v[50:51], v[50:51], v[28:29], v[30:31] op_sel_hi:[1,0,0]
  v_pk_fma_f32 v[52:53], v[52:53], v[28:29], v[30:31] op_sel_hi:[1,0,0]
  v_pk_fma_f32 v[54:55], v[54:55], v[28:29], v[30:31] op_sel_hi:[1,0,0]
  v_cvt_pk_bf16_f32 v72, v48, v49
  v_cvt_pk_bf16_f32 v73, v50, v51
  v_cvt_pk_bf16_f32 v74, v52, v53
  v_cvt_pk_bf16_f32 v75, v54, v55
  ds_write_b128 v26, v[72:75] offset:256
  s_cmp_lg_u32 s5, 0
  s_cbranch_scc1 NOLD_19
  buffer_load_dwordx4 v[196:199], v19, s[40:43], s10 offen offset:0
  buffer_load_dwordx4 v[200:203], v19, s[40:43], s10 offen offset:128
  buffer_load_dwordx4 v[204:207], v19, s[40:43], s10 offen offset:256
NOLD_19:
  s_cmp_lg_u32 s5, 0
  s_cbranch_scc1 AFW_20
  s_waitcnt vmcnt(6)
  s_branch AFW_21
AFW_20:
  s_waitcnt vmcnt(3)
AFW_21:
  s_waitcnt lgkmcnt(0)
  s_barrier
  s_mul_i32 s60, s4, 6144
  v_add_u32 v13, s60, v31
  ds_read_b128 v[208:211], v13 offset:0
  ds_read_b128 v[212:215], v13 offset:1024
  ds_read_b128 v[216:219], v13 offset:2048
  ds_read_b128 v[220:223], v13 offset:3072
  ds_read_b128 v[224:227], v13 offset:4096
  ds_read_b128 v[228:231], v13 offset:5120
  s_mul_i32 s60, s4, 1536
  v_lshlrev_b32 v13, 2, v1
  v_add_u32 v13, s60, v13
  ds_read_b32 v236, v13 offset:24576
  ds_read_b32 v237, v13 offset:24832
  ds_read_b32 v238, v13 offset:25088
  ds_read_b32 v239, v13 offset:25344
  ds_read_b32 v240, v13 offset:25600
  ds_read_b32 v241, v13 offset:25856
  s_mov_b32 s17, 0
  s_waitcnt lgkmcnt(0)
AFV_22:
  v_bitop3_b32 v13, v208, v209, v210 bitop3:0x96
  v_bitop3_b32 v13, v13, v211, s14 bitop3:0x96
  v_xor_b32 v15, v13, v236
  v_bitop3_b32 v13, v212, v213, v214 bitop3:0x96
  v_bitop3_b32 v13, v13, v215, s14 bitop3:0x96
  v_xor_b32 v13, v13, v237
  v_or_b32 v15, v15, v13
  v_bitop3_b32 v13, v216, v217, v218 bitop3:0x96
  v_bitop3_b32 v13, v13, v219, s14 bitop3:0x96
  v_xor_b32 v13, v13, v238
  v_or_b32 v15, v15, v13
  v_bitop3_b32 v13, v220, v221, v222 bitop3:0x96
  v_bitop3_b32 v13, v13, v223, s14 bitop3:0x96
  v_xor_b32 v13, v13, v239
  v_or_b32 v15, v15, v13
  v_bitop3_b32 v13, v224, v225, v226 bitop3:0x96
  v_bitop3_b32 v13, v13, v227, s14 bitop3:0x96
  v_xor_b32 v13, v13, v240
  v_or_b32 v15, v15, v13
  v_bitop3_b32 v13, v228, v229, v230 bitop3:0x96
  v_bitop3_b32 v13, v13, v231, s14 bitop3:0x96
  v_xor_b32 v13, v13, v241
  v_or_b32 v15, v15, v13
  v_cmp_ne_u32 vcc, 0, v15
  s_cbranch_vccz AFD_23
  s_add_u32 s17, s17, 1
  s_cmp_gt_u32 s17, 20000
  s_cbranch_scc1 AFD_23
  s_sleep 2
  s_mul_i32 s60, s4, 6144
  s_add_u32 s60, s60, 8192
  buffer_load_dwordx4 v[208:211], v31, s[56:59], s60 offen offset:0 sc1
  buffer_load_dwordx4 v[212:215], v31, s[56:59], s60 offen offset:1024 sc1
  buffer_load_dwordx4 v[216:219], v31, s[56:59], s60 offen offset:2048 sc1
  buffer_load_dwordx4 v[220:223], v31, s[56:59], s60 offen offset:3072 sc1
  s_add_u32 s60, s60, 4096
  buffer_load_dwordx4 v[224:227], v31, s[56:59], s60 offen offset:0 sc1
  buffer_load_dwordx4 v[228:231], v31, s[56:59], s60 offen offset:1024 sc1
  s_mul_i32 s60, s4, 1536
  s_add_u32 s60, s60, 32768
  v_lshlrev_b32 v13, 2, v1
  buffer_load_dword v236, v13, s[56:59], s60 offen offset:0 sc1
  buffer_load_dword v237, v13, s[56:59], s60 offen offset:256 sc1
  buffer_load_dword v238, v13, s[56:59], s60 offen offset:512 sc1
  buffer_load_dword v239, v13, s[56:59], s60 offen offset:768 sc1
  buffer_load_dword v240, v13, s[56:59], s60 offen offset:1024 sc1
  buffer_load_dword v241, v13, s[56:59], s60 offen offset:1280 sc1
  s_waitcnt vmcnt(0)
  s_branch AFV_22
AFD_23:
  v_mfma_f32_16x16x32_bf16 v[152:155], v[208:211], v[208:211], 0
  v_mfma_f32_16x16x32_bf16 v[152:155], v[212:215], v[212:215], v[152:155]
  v_mfma_f32_16x16x32_bf16 v[152:155], v[216:219], v[216:219], v[152:155]
  v_mfma_f32_16x16x32_bf16 v[152:155], v[220:223], v[220:223], v[152:155]
  v_mfma_f32_16x16x32_bf16 v[152:155], v[224:227], v[224:227], v[152:155]
  v_mfma_f32_16x16x32_bf16 v[152:155], v[228:231], v[228:231], v[152:155]
  s_cmp_eq_u32 s5, 0
  s_mov_b32 s12, 122880
  s_cselect_b32 s12, s12, 135168
  v_mov_b32 v17, 0
  s_mov_b32 s60, 0x42271447
  s_nop 2
  v_max3_f32 v13, v152, v153, v154
  v_max_f32 v13, v13, v155
  v_cmp_nge_f32 vcc, s60, v13
  s_nop 0
  s_cmp_lg_u64 vcc, 0
  s_cselect_b32 s36, 1, 0
  s_cmp_lg_u32 s36, 0
  s_cbranch_scc1 SAFE_IN0
  v_add_u32 v24, s12, v8
  v_add_u32 v25, s12, v9
  ds_read_b128 v[32:35], v24 offset:0
  ds_read_b128 v[56:59], v24 offset:6144
  ds_read_b128 v[36:39], v25 offset:0
  ds_read_b128 v[60:63], v25 offset:6144
  ds_read_b128 v[40:43], v24 offset:128
  ds_read_b128 v[64:67], v24 offset:6272
  ds_read_b128 v[44:47], v25 offset:128
  ds_read_b128 v[68:71], v25 offset:6272
  ds_read_b128 v[48:51], v24 offset:256
  ds_read_b128 v[72:75], v24 offset:6400
  ds_read_b128 v[52:55], v25 offset:256
  ds_read_b128 v[76:79], v25 offset:6400
  v_add_u32 v26, s12, v20
  v_add_u32 v27, s12, v21
  v_add_u32 v28, s12, v22
  v_add_u32 v29, s12, v23
  s_waitcnt lgkmcnt(11)
  v_mfma_f32_16x16x32_bf16 v[152:155], v[32:35], v[208:211], 0
  ds_read_b64_tr_b16 v[80:81], v26 offset:0
  s_waitcnt lgkmcnt(11)
  v_mfma_f32_16x16x32_bf16 v[156:159], v[56:59], v[208:211], 0
  ds_read_b64_tr_b16 v[82:83], v26 offset:6144
  s_waitcnt lgkmcnt(11)
  v_mfma_f32_16x16x32_bf16 v[152:155], v[36:39], v[212:215], v[152:155]
  s_waitcnt lgkmcnt(10)
  v_mfma_f32_16x16x32_bf16 v[156:159], v[60:63], v[212:215], v[156:159]
  ds_read_b64_tr_b16 v[84:85], v27 offset:0
  s_waitcnt lgkmcnt(10)
  v_mfma_f32_16x16x32_bf16 v[152:155], v[40:43], v[216:219], v[152:155]
  ds_read_b64_tr_b16 v[86:87], v27 offset:6144
  s_waitcnt lgkmcnt(10)
  v_mfma_f32_16x16x32_bf16 v[156:159], v[64:67], v[216:219], v[156:159]
  s_waitcnt lgkmcnt(9)
  v_mfma_f32_16x16x32_bf16 v[152:155], v[44:47], v[220:223], v[152:155]
  ds_read_b64_tr_b16 v[88:89], v28 offset:0
  s_waitcnt lgkmcnt(9)
  v_mfma_f32_16x16x32_bf16 v[156:159], v[68:71], v[220:223], v[156:159]
  ds_read_b64_tr_b16 v[90:91], v28 offset:6144
  s_waitcnt lgkmcnt(9)
  v_mfma_f32_16x16x32_bf16 v[152:155], v[48:51], v[224:227], v[152:155]
  s_waitcnt lgkmcnt(8)
  v_mfma_f32_16x16x32_bf16 v[156:159], v[72:75], v[224:227], v[156:159]
  ds_read_b64_tr_b16 v[92:93], v29 offset:0
  s_waitcnt lgkmcnt(8)
  v_mfma_f32_16x16x32_bf16 v[152:155], v[52:55], v[228:231], v[152:155]
  ds_read_b64_tr_b16 v[94:95], v29 offset:6144
  s_waitcnt lgkmcnt(8)
  v_mfma_f32_16x16x32_bf16 v[156:159], v[76:79], v[228:231], v[156:159]
  ds_read_b64_tr_b16 v[32:33], v26 offset:128
  s_nop 3
  v_exp_f32 v152, v152
  ds_read_b64_tr_b16 v[34:35], v26 offset:6272
  v_exp_f32 v153, v153
  ds_read_b64_tr_b16 v[36:37], v27 offset:128
  v_exp_f32 v154, v154
  ds_read_b64_tr_b16 v[38:39], v27 offset:6272
  v_exp_f32 v155, v155
  ds_read_b64_tr_b16 v[40:41], v28 offset:128
  v_exp_f32 v156, v156
  ds_read_b64_tr_b16 v[42:43], v28 offset:6272
  v_exp_f32 v157, v157
  ds_read_b64_tr_b16 v[44:45], v29 offset:128
  v_exp_f32 v158, v158
  ds_read_b64_tr_b16 v[46:47], v29 offset:6272
  v_exp_f32 v159, v159
  ds_read_b64_tr_b16 v[48:49], v26 offset:256
  v_cvt_pk_bf16_f32 v232, v152, v153
  ds_read_b64_tr_b16 v[50:51], v26 offset:6400
  v_cvt_pk_bf16_f32 v233, v154, v155
  ds_read_b64_tr_b16 v[52:53], v27 offset:256
  v_cvt_pk_bf16_f32 v234, v156, v157
  ds_read_b64_tr_b16 v[54:55], v27 offset:6400
  v_cvt_pk_bf16_f32 v235, v158, v159
  s_waitcnt lgkmcnt(15)
  s_nop 0
  v_mfma_f32_16x16x32_bf16 v[96:99], v[80:83], v[232:235], 0
  ds_read_b64_tr_b16 v[56:57], v28 offset:256
  s_waitcnt lgkmcnt(15)
  v_mfma_f32_16x16x32_bf16 v[100:103], v[84:87], v[232:235], 0
  ds_read_b64_tr_b16 v[58:59], v28 offset:6400
  s_waitcnt lgkmcnt(15)
  v_mfma_f32_16x16x32_bf16 v[104:107], v[88:91], v[232:235], 0
  ds_read_b64_tr_b16 v[60:61], v29 offset:256
  s_waitcnt lgkmcnt(15)
  v_mfma_f32_16x16x32_bf16 v[108:111], v[92:95], v[232:235], 0
  ds_read_b64_tr_b16 v[62:63], v29 offset:6400
  s_waitcnt lgkmcnt(14)
  v_mfma_f32_16x16x32_bf16 v[112:115], v[32:35], v[232:235], 0
  s_waitcnt lgkmcnt(12)
  v_mfma_f32_16x16x32_bf16 v[116:119], v[36:39], v[232:235], 0
  s_waitcnt lgkmcnt(10)
  v_mfma_f32_16x16x32_bf16 v[120:123], v[40:43], v[232:235], 0
  s_waitcnt lgkmcnt(8)
  v_mfma_f32_16x16x32_bf16 v[124:127], v[44:47], v[232:235], 0
  s_waitcnt lgkmcnt(6)
  v_mfma_f32_16x16x32_bf16 v[128:131], v[48:51], v[232:235], 0
  s_waitcnt lgkmcnt(4)
  v_mfma_f32_16x16x32_bf16 v[132:135], v[52:55], v[232:235], 0
  s_waitcnt lgkmcnt(2)
  v_mfma_f32_16x16x32_bf16 v[136:139], v[56:59], v[232:235], 0
  s_waitcnt lgkmcnt(0)
  v_mfma_f32_16x16x32_bf16 v[140:143], v[60:63], v[232:235], 0
  v_mfma_f32_16x16x32_bf16 v[144:147], v[148:151], v[232:235], 0
SAFE_RET0:
  s_barrier
  s_add_u32 s62, s11, 0
  s_mov_b32 m0, s62
  s_add_u32 s63, s11, 0
  buffer_load_dwordx4 v31, s[52:55], s63 offen lds
  s_add_u32 s62, s11, 1024
  s_mov_b32 m0, s62
  s_add_u32 s63, s11, 1024
  buffer_load_dwordx4 v31, s[52:55], s63 offen lds
  s_add_u32 s62, s11, 2048
  s_mov_b32 m0, s62
  s_add_u32 s63, s11, 2048
  buffer_load_dwordx4 v31, s[52:55], s63 offen lds
  s_cmp_eq_u32 s5, 0
  s_mov_b32 s12, 73728
  s_cselect_b32 s12, s12, 147456
  s_cmp_lg_u32 s36, 0
  s_cbranch_scc1 SAFE_IN1
  v_add_u32 v24, s12, v8
  v_add_u32 v25, s12, v9
  ds_read_b128 v[32:35], v24 offset:0
  ds_read_b128 v[56:59], v24 offset:6144
  ds_read_b128 v[36:39], v25 offset:0
  ds_read_b128 v[60:63], v25 offset:6144
  ds_read_b128 v[40:43], v24 offset:128
  ds_read_b128 v[64:67], v24 offset:6272
  ds_read_b128 v[44:47], v25 offset:128
  ds_read_b128 v[68:71], v25 offset:6272
  ds_read_b128 v[48:51], v24 offset:256
  ds_read_b128 v[72:75], v24 offset:6400
  ds_read_b128 v[52:55], v25 offset:256
  ds_read_b128 v[76:79], v25 offset:6400
  v_add_u32 v26, s12, v20
  v_add_u32 v27, s12, v21
  v_add_u32 v28, s12, v22
  v_add_u32 v29, s12, v23
  s_waitcnt lgkmcnt(11)
  v_mfma_f32_16x16x32_bf16 v[152:155], v[32:35], v[208:211], 0
  ds_read_b64_tr_b16 v[80:81], v26 offset:0
  s_waitcnt lgkmcnt(11)
  v_mfma_f32_16x16x32_bf16 v[156:159], v[56:59], v[208:211], 0
  ds_read_b64_tr_b16 v[82:83], v26 offset:6144
  s_waitcnt lgkmcnt(11)
  v_mfma_f32_16x16x32_bf16 v[152:155], v[36:39], v[212:215], v[152:155]
  s_waitcnt lgkmcnt(10)
  v_mfma_f32_16x16x32_bf16 v[156:159], v[60:63], v[212:215], v[156:159]
  ds_read_b64_tr_b16 v[84:85], v27 offset:0
  s_waitcnt lgkmcnt(10)
  v_mfma_f32_16x16x32_bf16 v[152:155], v[40:43], v[216:219], v[152:155]
  ds_read_b64_tr_b16 v[86:87], v27 offset:6144
  s_waitcnt lgkmcnt(10)
  v_mfma_f32_16x16x32_bf16 v[156:159], v[64:67], v[216:219], v[156:159]
  s_waitcnt lgkmcnt(9)
  v_mfma_f32_16x16x32_bf16 v[152:155], v[44:47], v[220:223], v[152:155]
  ds_read_b64_tr_b16 v[88:89], v28 offset:0
  s_waitcnt lgkmcnt(9)
  v_mfma_f32_16x16x32_bf16 v[156:159], v[68:71], v[220:223], v[156:159]
  ds_read_b64_tr_b16 v[90:91], v28 offset:6144
  s_waitcnt lgkmcnt(9)
  v_mfma_f32_16x16x32_bf16 v[152:155], v[48:51], v[224:227], v[152:155]
  s_waitcnt lgkmcnt(8)
  v_mfma_f32_16x16x32_bf16 v[156:159], v[72:75], v[224:227], v[156:159]
  ds_read_b64_tr_b16 v[92:93], v29 offset:0
  s_waitcnt lgkmcnt(8)
  v_mfma_f32_16x16x32_bf16 v[152:155], v[52:55], v[228:231], v[152:155]
  ds_read_b64_tr_b16 v[94:95], v29 offset:6144
  s_waitcnt lgkmcnt(8)
  v_mfma_f32_16x16x32_bf16 v[156:159], v[76:79], v[228:231], v[156:159]
  ds_read_b64_tr_b16 v[32:33], v26 offset:128
  s_nop 3
  v_exp_f32 v152, v152
  ds_read_b64_tr_b16 v[34:35], v26 offset:6272
  v_exp_f32 v153, v153
  ds_read_b64_tr_b16 v[36:37], v27 offset:128
  v_exp_f32 v154, v154
  ds_read_b64_tr_b16 v[38:39], v27 offset:6272
  v_exp_f32 v155, v155
  ds_read_b64_tr_b16 v[40:41], v28 offset:128
  v_exp_f32 v156, v156
  ds_read_b64_tr_b16 v[42:43], v28 offset:6272
  v_exp_f32 v157, v157
  ds_read_b64_tr_b16 v[44:45], v29 offset:128
  v_exp_f32 v158, v158
  ds_read_b64_tr_b16 v[46:47], v29 offset:6272
  v_exp_f32 v159, v159
  ds_read_b64_tr_b16 v[48:49], v26 offset:256
  v_cvt_pk_bf16_f32 v232, v152, v153
  ds_read_b64_tr_b16 v[50:51], v26 offset:6400
  v_cvt_pk_bf16_f32 v233, v154, v155
  ds_read_b64_tr_b16 v[52:53], v27 offset:256
  v_cvt_pk_bf16_f32 v234, v156, v157
  ds_read_b64_tr_b16 v[54:55], v27 offset:6400
  v_cvt_pk_bf16_f32 v235, v158, v159
  s_waitcnt lgkmcnt(15)
  s_nop 0
  v_mfma_f32_16x16x32_bf16 v[96:99], v[80:83], v[232:235], v[96:99]
  ds_read_b64_tr_b16 v[56:57], v28 offset:256
  s_waitcnt lgkmcnt(15)
  v_mfma_f32_16x16x32_bf16 v[100:103], v[84:87], v[232:235], v[100:103]
  ds_read_b64_tr_b16 v[58:59], v28 offset:6400
  s_waitcnt lgkmcnt(15)
  v_mfma_f32_16x16x32_bf16 v[104:107], v[88:91], v[232:235], v[104:107]
  ds_read_b64_tr_b16 v[60:61], v29 offset:256
  s_waitcnt lgkmcnt(15)
  v_mfma_f32_16x16x32_bf16 v[108:111], v[92:95], v[232:235], v[108:111]
  ds_read_b64_tr_b16 v[62:63], v29 offset:6400
  s_waitcnt lgkmcnt(14)
  v_mfma_f32_16x16x32_bf16 v[112:115], v[32:35], v[232:235], v[112:115]
  s_waitcnt lgkmcnt(12)
  v_mfma_f32_16x16x32_bf16 v[116:119], v[36:39], v[232:235], v[116:119]
  s_mul_i32 s60, s4, 3072
  s_add_u32 s60, s60, 98304
  v_add_u32 v13, s60, v10
  v_add_u32 v15, s60, v11
  ds_read_b128 v[64:67], v13 offset:0
  ds_read_b128 v[68:71], v15 offset:0
  ds_read_b128 v[72:75], v13 offset:256
  ds_read_b128 v[76:79], v15 offset:256
  ds_read_b128 v[80:83], v13 offset:512
  ds_read_b128 v[84:87], v15 offset:512
  s_waitcnt lgkmcnt(15)
  v_mfma_f32_16x16x32_bf16 v[120:123], v[40:43], v[232:235], v[120:123]
  s_waitcnt lgkmcnt(14)
  v_mfma_f32_16x16x32_bf16 v[124:127], v[44:47], v[232:235], v[124:127]
  s_waitcnt lgkmcnt(12)
  v_mfma_f32_16x16x32_bf16 v[128:131], v[48:51], v[232:235], v[128:131]
  s_waitcnt lgkmcnt(10)
  v_mfma_f32_16x16x32_bf16 v[132:135], v[52:55], v[232:235], v[132:135]
  s_waitcnt lgkmcnt(8)
  v_mfma_f32_16x16x32_bf16 v[136:139], v[56:59], v[232:235], v[136:139]
  s_waitcnt lgkmcnt(6)
  v_mfma_f32_16x16x32_bf16 v[140:143], v[60:63], v[232:235], v[140:143]
  v_mfma_f32_16x16x32_bf16 v[144:147], v[148:151], v[232:235], v[144:147]
SAFE_RET1:
  s_add_u32 s62, s11, 3072
  s_mov_b32 m0, s62
  s_add_u32 s63, s11, 3072
  buffer_load_dwordx4 v31, s[52:55], s63 offen lds
  s_add_u32 s62, s11, 4096
  s_mov_b32 m0, s62
  s_add_u32 s63, s11, 4096
  buffer_load_dwordx4 v31, s[52:55], s63 offen lds
  s_add_u32 s62, s11, 5120
  s_mov_b32 m0, s62
  s_add_u32 s63, s11, 5120
  buffer_load_dwordx4 v31, s[52:55], s63 offen lds
  s_cmp_eq_u32 s5, 0
  s_mov_b32 s12, 122880
  s_cselect_b32 s12, s12, 135168
  v_add_u32 v26, s12, v12
  s_waitcnt vmcnt(8) lgkmcnt(5)
  v_dot2_f32_bf16 v32, v184, s64, v64
  v_dot2_f32_bf16 v33, v184, s65, v65
  v_dot2_f32_bf16 v34, v185, s64, v66
  v_dot2_f32_bf16 v35, v185, s65, v67
  v_pk_mul_f32 v[92:93], v[32:33], v[32:33]
  s_waitcnt lgkmcnt(4)
  v_dot2_f32_bf16 v36, v186, s64, v68
  v_dot2_f32_bf16 v37, v186, s65, v69
  v_pk_add_f32 v[94:95], v[32:33], v[34:35]
  v_pk_fma_f32 v[92:93], v[34:35], v[34:35], v[92:93]
  v_dot2_f32_bf16 v38, v187, s64, v70
  v_dot2_f32_bf16 v39, v187, s65, v71
  v_pk_add_f32 v[94:95], v[94:95], v[36:37]
  v_pk_fma_f32 v[92:93], v[36:37], v[36:37], v[92:93]
  s_waitcnt vmcnt(7) lgkmcnt(3)
  v_dot2_f32_bf16 v40, v188, s64, v72
  v_dot2_f32_bf16 v41, v188, s65, v73
  v_pk_add_f32 v[94:95], v[94:95], v[38:39]
  v_pk_fma_f32 v[92:93], v[38:39], v[38:39], v[92:93]
  v_dot2_f32_bf16 v42, v189, s64, v74
  v_dot2_f32_bf16 v43, v189, s65, v75
  v_pk_add_f32 v[94:95], v[94:95], v[40:41]
  v_pk_fma_f32 v[92:93], v[40:41], v[40:41], v[92:93]
  s_waitcnt lgkmcnt(2)
  v_dot2_f32_bf16 v44, v190, s64, v76
  v_dot2_f32_bf16 v45, v190, s65, v77
  v_pk_add_f32 v[94:95], v[94:95], v[42:43]
  v_pk_fma_f32 v[92:93], v[42:43], v[42:43], v[92:93]
  v_dot2_f32_bf16 v46, v191, s64, v78
  v_dot2_f32_bf16 v47, v191, s65, v79
  v_pk_add_f32 v[94:95], v[94:95], v[44:45]
  v_pk_fma_f32 v[92:93], v[44:45], v[44:45], v[92:93]
  s_waitcnt vmcnt(6) lgkmcnt(1)
  v_dot2_f32_bf16 v48, v192, s64, v80
  v_dot2_f32_bf16 v49, v192, s65, v81
  v_pk_add_f32 v[94:95], v[94:95], v[46:47]
  v_pk_fma_f32 v[92:93], v[46:47], v[46:47], v[92:93]
  v_dot2_f32_bf16 v50, v193, s64, v82
  v_dot2_f32_bf16 v51, v193, s65, v83
  v_pk_add_f32 v[94:95], v[94:95], v[48:49]
  v_pk_fma_f32 v[92:93], v[48:49], v[48:49], v[92:93]
  s_waitcnt lgkmcnt(0)
  v_dot2_f32_bf16 v52, v194, s64, v84
  v_dot2_f32_bf16 v53, v194, s65, v85
  v_pk_add_f32 v[94:95], v[94:95], v[50:51]
  v_pk_fma_f32 v[92:93], v[50:51], v[50:51], v[92:93]
  v_dot2_f32_bf16 v54, v195, s64, v86
  v_dot2_f32_bf16 v55, v195, s65, v87
  v_pk_add_f32 v[94:95], v[94:95], v[52:53]
  v_pk_fma_f32 v[92:93], v[52:53], v[52:53], v[92:93]
  v_pk_add_f32 v[94:95], v[94:95], v[54:55]
  v_pk_fma_f32 v[92:93], v[54:55], v[54:55], v[92:93]
  v_add_f32 v94, v94, v95
  v_add_f32 v92, v92, v93
  s_nop 0
  v_add_f32_dpp v94, v94, v94 quad_perm:[1,0,3,2] row_mask:0xf bank_mask:0xf
  v_add_f32_dpp v92, v92, v92 quad_perm:[1,0,3,2] row_mask:0xf bank_mask:0xf
  s_nop 0
  v_add_f32_dpp v94, v94, v94 quad_perm:[2,3,0,1] row_mask:0xf bank_mask:0xf
  v_add_f32_dpp v92, v92, v92 quad_perm:[2,3,0,1] row_mask:0xf bank_mask:0xf
  s_nop 0
  v_add_f32_dpp v94, v94, v94 row_half_mirror row_mask:0xf bank_mask:0xf
  v_add_f32_dpp v92, v92, v92 row_half_mirror row_mask:0xf bank_mask:0xf
  v_mul_f32 v94, s7, v94
  v_mul_f32 v95, v94, v94
  v_fma_f32 v92, v92, s7, -v95
  v_add_f32 v92, 0x3727c5ac, v92
  v_rsq_f32 v28, v92
  s_nop 0
  v_mul_f32 v30, -v94, v28
  v_pk_fma_f32 v[32:33], v[32:33], v[28:29], v[30:31] op_sel_hi:[1,0,0]
  v_pk_fma_f32 v[34:35], v[34:35], v[28:29], v[30:31] op_sel_hi:[1,0,0]
  v_pk_fma_f32 v[36:37], v[36:37], v[28:29], v[30:31] op_sel_hi:[1,0,0]
  v_pk_fma_f32 v[38:39], v[38:39], v[28:29], v[30:31] op_sel_hi:[1,0,0]
  v_cvt_pk_bf16_f32 v64, v32, v33
  v_cvt_pk_bf16_f32 v65, v34, v35
  v_cvt_pk_bf16_f32 v66, v36, v37
  v_cvt_pk_bf16_f32 v67, v38, v39
  ds_write_b128 v26, v[64:67] offset:0
  v_pk_fma_f32 v[40:41], v[40:41], v[28:29], v[30:31] op_sel_hi:[1,0,0]
  v_pk_fma_f32 v[42:43], v[42:43], v[28:29], v[30:31] op_sel_hi:[1,0,0]
  v_pk_fma_f32 v[44:45], v[44:45], v[28:29], v[30:31] op_sel_hi:[1,0,0]
  v_pk_fma_f32 v[46:47], v[46:47], v[28:29], v[30:31] op_sel_hi:[1,0,0]
  v_cvt_pk_bf16_f32 v68, v40, v41
  v_cvt_pk_bf16_f32 v69, v42, v43
  v_cvt_pk_bf16_f32 v70, v44, v45
  v_cvt_pk_bf16_f32 v71, v46, v47
  ds_write_b128 v26, v[68:71] offset:128
  v_pk_fma_f32 v[48:49], v[48:49], v[28:29], v[30:31] op_sel_hi:[1,0,0]
  v_pk_fma_f32 v[50:51], v[50:51], v[28:29], v[30:31] op_sel_hi:[1,0,0]
  v_pk_fma_f32 v[52:53], v[52:53], v[28:29], v[30:31] op_sel_hi:[1,0,0]
  v_pk_fma_f32 v[54:55], v[54:55], v[28:29], v[30:31] op_sel_hi:[1,0,0]
  v_cvt_pk_bf16_f32 v72, v48, v49
  v_cvt_pk_bf16_f32 v73, v50, v51
  v_cvt_pk_bf16_f32 v74, v52, v53
  v_cvt_pk_bf16_f32 v75, v54, v55
  ds_write_b128 v26, v[72:75] offset:256
  s_add_u32 s62, s11, 6144
  s_mov_b32 m0, s62
  s_add_u32 s63, s11, 6144
  buffer_load_dwordx4 v31, s[52:55], s63 offen lds
  s_add_u32 s62, s11, 7168
  s_mov_b32 m0, s62
  s_add_u32 s63, s11, 7168
  buffer_load_dwordx4 v31, s[52:55], s63 offen lds
  s_add_u32 s62, s11, 8192
  s_mov_b32 m0, s62
  s_add_u32 s63, s11, 8192
  buffer_load_dwordx4 v31, s[52:55], s63 offen lds
  s_waitcnt lgkmcnt(0)
  s_barrier
  s_cmp_lg_u32 s36, 0
  s_cbranch_scc1 SAFE_IN2
  v_add_u32 v24, s12, v8
  v_add_u32 v25, s12, v9
  ds_read_b128 v[32:35], v24 offset:0
  ds_read_b128 v[56:59], v24 offset:6144
  ds_read_b128 v[36:39], v25 offset:0
  ds_read_b128 v[60:63], v25 offset:6144
  ds_read_b128 v[40:43], v24 offset:128
  ds_read_b128 v[64:67], v24 offset:6272
  ds_read_b128 v[44:47], v25 offset:128
  ds_read_b128 v[68:71], v25 offset:6272
  ds_read_b128 v[48:51], v24 offset:256
  ds_read_b128 v[72:75], v24 offset:6400
  ds_read_b128 v[52:55], v25 offset:256
  ds_read_b128 v[76:79], v25 offset:6400
  v_add_u32 v26, s12, v20
  v_add_u32 v27, s12, v21
  v_add_u32 v28, s12, v22
  v_add_u32 v29, s12, v23
  s_waitcnt lgkmcnt(11)
  v_mfma_f32_16x16x32_bf16 v[152:155], v[32:35], v[208:211], 0
  ds_read_b64_tr_b16 v[80:81], v26 offset:0
  s_waitcnt lgkmcnt(11)
  v_mfma_f32_16x16x32_bf16 v[156:159], v[56:59], v[208:211], 0
  ds_read_b64_tr_b16 v[82:83], v26 offset:6144
  s_waitcnt lgkmcnt(11)
  v_mfma_f32_16x16x32_bf16 v[152:155], v[36:39], v[212:215], v[152:155]
  s_waitcnt lgkmcnt(10)
  v_mfma_f32_16x16x32_bf16 v[156:159], v[60:63], v[212:215], v[156:159]
  ds_read_b64_tr_b16 v[84:85], v27 offset:0
  s_waitcnt lgkmcnt(10)
  v_mfma_f32_16x16x32_bf16 v[152:155], v[40:43], v[216:219], v[152:155]
  ds_read_b64_tr_b16 v[86:87], v27 offset:6144
  s_waitcnt lgkmcnt(10)
  v_mfma_f32_16x16x32_bf16 v[156:159], v[64:67], v[216:219], v[156:159]
  s_waitcnt lgkmcnt(9)
  v_mfma_f32_16x16x32_bf16 v[152:155], v[44:47], v[220:223], v[152:155]
  ds_read_b64_tr_b16 v[88:89], v28 offset:0
  s_waitcnt lgkmcnt(9)
  v_mfma_f32_16x16x32_bf16 v[156:159], v[68:71], v[220:223], v[156:159]
  ds_read_b64_tr_b16 v[90:91], v28 offset:6144
  s_waitcnt lgkmcnt(9)
  v_mfma_f32_16x16x32_bf16 v[152:155], v[48:51], v[224:227], v[152:155]
  s_waitcnt lgkmcnt(8)
  v_mfma_f32_16x16x32_bf16 v[156:159], v[72:75], v[224:227], v[156:159]
  ds_read_b64_tr_b16 v[92:93], v29 offset:0
  s_waitcnt lgkmcnt(8)
  v_mfma_f32_16x16x32_bf16 v[152:155], v[52:55], v[228:231], v[152:155]
  ds_read_b64_tr_b16 v[94:95], v29 offset:6144
  s_waitcnt lgkmcnt(8)
  v_mfma_f32_16x16x32_bf16 v[156:159], v[76:79], v[228:231], v[156:159]
  ds_read_b64_tr_b16 v[32:33], v26 offset:128
  s_nop 3
  v_exp_f32 v152, v152
  ds_read_b64_tr_b16 v[34:35], v26 offset:6272
  v_exp_f32 v153, v153
  ds_read_b64_tr_b16 v[36:37], v27 offset:128
  v_exp_f32 v154, v154
  ds_read_b64_tr_b16 v[38:39], v27 offset:6272
  v_exp_f32 v155, v155
  ds_read_b64_tr_b16 v[40:41], v28 offset:128
  v_exp_f32 v156, v156
  ds_read_b64_tr_b16 v[42:43], v28 offset:6272
  v_exp_f32 v157, v157
  ds_read_b64_tr_b16 v[44:45], v29 offset:128
  v_exp_f32 v158, v158
  ds_read_b64_tr_b16 v[46:47], v29 offset:6272
  v_exp_f32 v159, v159
  ds_read_b64_tr_b16 v[48:49], v26 offset:256
  v_cvt_pk_bf16_f32 v232, v152, v153
  ds_read_b64_tr_b16 v[50:51], v26 offset:6400
  v_cvt_pk_bf16_f32 v233, v154, v155
  ds_read_b64_tr_b16 v[52:53], v27 offset:256
  v_cvt_pk_bf16_f32 v234, v156, v157
  ds_read_b64_tr_b16 v[54:55], v27 offset:6400
  v_cvt_pk_bf16_f32 v235, v158, v159
  s_waitcnt lgkmcnt(15)
  s_nop 0
  v_mfma_f32_16x16x32_bf16 v[96:99], v[80:83], v[232:235], v[96:99]
  ds_read_b64_tr_b16 v[56:57], v28 offset:256
  s_waitcnt lgkmcnt(15)
  v_mfma_f32_16x16x32_bf16 v[100:103], v[84:87], v[232:235], v[100:103]
  ds_read_b64_tr_b16 v[58:59], v28 offset:6400
  s_waitcnt lgkmcnt(15)
  v_mfma_f32_16x16x32_bf16 v[104:107], v[88:91], v[232:235], v[104:107]
  ds_read_b64_tr_b16 v[60:61], v29 offset:256
  s_waitcnt lgkmcnt(15)
  v_mfma_f32_16x16x32_bf16 v[108:111], v[92:95], v[232:235], v[108:111]
  ds_read_b64_tr_b16 v[62:63], v29 offset:6400
  s_waitcnt lgkmcnt(14)
  v_mfma_f32_16x16x32_bf16 v[112:115], v[32:35], v[232:235], v[112:115]
  s_waitcnt lgkmcnt(12)
  v_mfma_f32_16x16x32_bf16 v[116:119], v[36:39], v[232:235], v[116:119]
  s_and_b32 s60, s3, 1
  s_mul_i32 s60, s60, 3072
  s_add_u32 s60, s60, 110592
  v_add_u32 v13, s60, v10
  v_add_u32 v15, s60, v11
  ds_read_b128 v[64:67], v13 offset:0
  ds_read_b128 v[68:71], v15 offset:0
  ds_read_b128 v[72:75], v13 offset:256
  ds_read_b128 v[76:79], v15 offset:256
  ds_read_b128 v[80:83], v13 offset:512
  ds_read_b128 v[84:87], v15 offset:512
  s_waitcnt lgkmcnt(15)
  v_mfma_f32_16x16x32_bf16 v[120:123], v[40:43], v[232:235], v[120:123]
  s_waitcnt lgkmcnt(14)
  v_mfma_f32_16x16x32_bf16 v[124:127], v[44:47], v[232:235], v[124:127]
  s_waitcnt lgkmcnt(12)
  v_mfma_f32_16x16x32_bf16 v[128:131], v[48:51], v[232:235], v[128:131]
  s_waitcnt lgkmcnt(10)
  v_mfma_f32_16x16x32_bf16 v[132:135], v[52:55], v[232:235], v[132:135]
  s_waitcnt lgkmcnt(8)
  v_mfma_f32_16x16x32_bf16 v[136:139], v[56:59], v[232:235], v[136:139]
  s_waitcnt lgkmcnt(6)
  v_mfma_f32_16x16x32_bf16 v[140:143], v[60:63], v[232:235], v[140:143]
  v_mfma_f32_16x16x32_bf16 v[144:147], v[148:151], v[232:235], v[144:147]
SAFE_RET2:
  s_cmp_lg_u32 s5, 0
  s_cbranch_scc1 KK1
  s_waitcnt vmcnt(9)
  s_mov_b32 s12, 86016
  v_add_u32 v26, s12, v12
  s_waitcnt lgkmcnt(5)
  v_dot2_f32_bf16 v32, v196, s64, v64
  v_dot2_f32_bf16 v33, v196, s65, v65
  v_dot2_f32_bf16 v34, v197, s64, v66
  v_dot2_f32_bf16 v35, v197, s65, v67
  v_pk_mul_f32 v[92:93], v[32:33], v[32:33]
  s_waitcnt lgkmcnt(4)
  v_dot2_f32_bf16 v36, v198, s64, v68
  v_dot2_f32_bf16 v37, v198, s65, v69
  v_pk_add_f32 v[94:95], v[32:33], v[34:35]
  v_pk_fma_f32 v[92:93], v[34:35], v[34:35], v[92:93]
  v_dot2_f32_bf16 v38, v199, s64, v70
  v_dot2_f32_bf16 v39, v199, s65, v71
  v_pk_add_f32 v[94:95], v[94:95], v[36:37]
  v_pk_fma_f32 v[92:93], v[36:37], v[36:37], v[92:93]
  s_waitcnt lgkmcnt(3)
  v_dot2_f32_bf16 v40, v200, s64, v72
  v_dot2_f32_bf16 v41, v200, s65, v73
  v_pk_add_f32 v[94:95], v[94:95], v[38:39]
  v_pk_fma_f32 v[92:93], v[38:39], v[38:39], v[92:93]
  v_dot2_f32_bf16 v42, v201, s64, v74
  v_dot2_f32_bf16 v43, v201, s65, v75
  v_pk_add_f32 v[94:95], v[94:95], v[40:41]
  v_pk_fma_f32 v[92:93], v[40:41], v[40:41], v[92:93]
  s_waitcnt lgkmcnt(2)
  v_dot2_f32_bf16 v44, v202, s64, v76
  v_dot2_f32_bf16 v45, v202, s65, v77
  v_pk_add_f32 v[94:95], v[94:95], v[42:43]
  v_pk_fma_f32 v[92:93], v[42:43], v[42:43], v[92:93]
  v_dot2_f32_bf16 v46, v203, s64, v78
  v_dot2_f32_bf16 v47, v203, s65, v79
  v_pk_add_f32 v[94:95], v[94:95], v[44:45]
  v_pk_fma_f32 v[92:93], v[44:45], v[44:45], v[92:93]
  s_waitcnt lgkmcnt(1)
  v_dot2_f32_bf16 v48, v204, s64, v80
  v_dot2_f32_bf16 v49, v204, s65, v81
  v_pk_add_f32 v[94:95], v[94:95], v[46:47]
  v_pk_fma_f32 v[92:93], v[46:47], v[46:47], v[92:93]
  v_dot2_f32_bf16 v50, v205, s64, v82
  v_dot2_f32_bf16 v51, v205, s65, v83
  v_pk_add_f32 v[94:95], v[94:95], v[48:49]
  v_pk_fma_f32 v[92:93], v[48:49], v[48:49], v[92:93]
  s_waitcnt lgkmcnt(0)
  v_dot2_f32_bf16 v52, v206, s64, v84
  v_dot2_f32_bf16 v53, v206, s65, v85
  v_pk_add_f32 v[94:95], v[94:95], v[50:51]
  v_pk_fma_f32 v[92:93], v[50:51], v[50:51], v[92:93]
  v_dot2_f32_bf16 v54, v207, s64, v86
  v_dot2_f32_bf16 v55, v207, s65, v87
  v_pk_add_f32 v[94:95], v[94:95], v[52:53]
  v_pk_fma_f32 v[92:93], v[52:53], v[52:53], v[92:93]
  v_pk_add_f32 v[94:95], v[94:95], v[54:55]
  v_pk_fma_f32 v[92:93], v[54:55], v[54:55], v[92:93]
  v_add_f32 v94, v94, v95
  v_add_f32 v92, v92, v93
  s_nop 0
  v_add_f32_dpp v94, v94, v94 quad_perm:[1,0,3,2] row_mask:0xf bank_mask:0xf
  v_add_f32_dpp v92, v92, v92 quad_perm:[1,0,3,2] row_mask:0xf bank_mask:0xf
  s_nop 0
  v_add_f32_dpp v94, v94, v94 quad_perm:[2,3,0,1] row_mask:0xf bank_mask:0xf
  v_add_f32_dpp v92, v92, v92 quad_perm:[2,3,0,1] row_mask:0xf bank_mask:0xf
  s_nop 0
  v_add_f32_dpp v94, v94, v94 row_half_mirror row_mask:0xf bank_mask:0xf
  v_add_f32_dpp v92, v92, v92 row_half_mirror row_mask:0xf bank_mask:0xf
  v_mul_f32 v94, s7, v94
  v_mul_f32 v95, v94, v94
  v_fma_f32 v92, v92, s7, -v95
  v_add_f32 v92, 0x3727c5ac, v92
  v_rsq_f32 v28, v92
  s_nop 0
  v_mul_f32 v30, -v94, v28
  v_pk_fma_f32 v[32:33], v[32:33], v[28:29], v[30:31] op_sel_hi:[1,0,0]
  v_pk_fma_f32 v[34:35], v[34:35], v[28:29], v[30:31] op_sel_hi:[1,0,0]
  v_pk_fma_f32 v[36:37], v[36:37], v[28:29], v[30:31] op_sel_hi:[1,0,0]
  v_pk_fma_f32 v[38:39], v[38:39], v[28:29], v[30:31] op_sel_hi:[1,0,0]
  v_cvt_pk_bf16_f32 v64, v32, v33
  v_cvt_pk_bf16_f32 v65, v34, v35
  v_cvt_pk_bf16_f32 v66, v36, v37
  v_cvt_pk_bf16_f32 v67, v38, v39
  ds_write_b128 v26, v[64:67] offset:0
  v_pk_fma_f32 v[40:41], v[40:41], v[28:29], v[30:31] op_sel_hi:[1,0,0]
  v_pk_fma_f32 v[42:43], v[42:43], v[28:29], v[30:31] op_sel_hi:[1,0,0]
  v_pk_fma_f32 v[44:45], v[44:45], v[28:29], v[30:31] op_sel_hi:[1,0,0]
  v_pk_fma_f32 v[46:47], v[46:47], v[28:29], v[30:31] op_sel_hi:[1,0,0]
  v_cvt_pk_bf16_f32 v68, v40, v41
  v_cvt_pk_bf16_f32 v69, v42, v43
  v_cvt_pk_bf16_f32 v70, v44, v45
  v_cvt_pk_bf16_f32 v71, v46, v47
  ds_write_b128 v26, v[68:71] offset:128
  v_pk_fma_f32 v[48:49], v[48:49], v[28:29], v[30:31] op_sel_hi:[1,0,0]
  v_pk_fma_f32 v[50:51], v[50:51], v[28:29], v[30:31] op_sel_hi:[1,0,0]
  v_pk_fma_f32 v[52:53], v[52:53], v[28:29], v[30:31] op_sel_hi:[1,0,0]
  v_pk_fma_f32 v[54:55], v[54:55], v[28:29], v[30:31] op_sel_hi:[1,0,0]
  v_cvt_pk_bf16_f32 v72, v48, v49
  v_cvt_pk_bf16_f32 v73, v50, v51
  v_cvt_pk_bf16_f32 v74, v52, v53
  v_cvt_pk_bf16_f32 v75, v54, v55
  ds_write_b128 v26, v[72:75] offset:256
  s_waitcnt vmcnt(0) lgkmcnt(0)
  s_barrier
  buffer_load_dword v15, v18, s[56:59], s16 offen sc1
  s_cmp_lg_u32 s36, 0
  s_cbranch_scc1 SAFE_IN3
  v_add_u32 v24, s12, v8
  v_add_u32 v25, s12, v9
  ds_read_b128 v[32:35], v24 offset:0
  ds_read_b128 v[56:59], v24 offset:6144
  ds_read_b128 v[36:39], v25 offset:0
  ds_read_b128 v[60:63], v25 offset:6144
  ds_read_b128 v[40:43], v24 offset:128
  ds_read_b128 v[64:67], v24 offset:6272
  ds_read_b128 v[44:47], v25 offset:128
  ds_read_b128 v[68:71], v25 offset:6272
  ds_read_b128 v[48:51], v24 offset:256
  ds_read_b128 v[72:75], v24 offset:6400
  ds_read_b128 v[52:55], v25 offset:256
  ds_read_b128 v[76:79], v25 offset:6400
  v_add_u32 v26, s12, v20
  v_add_u32 v27, s12, v21
  v_add_u32 v28, s12, v22
  v_add_u32 v29, s12, v23
  s_waitcnt lgkmcnt(11)
  v_mfma_f32_16x16x32_bf16 v[152:155], v[32:35], v[208:211], 0
  ds_read_b64_tr_b16 v[80:81], v26 offset:0
  s_waitcnt lgkmcnt(11)
  v_mfma_f32_16x16x32_bf16 v[156:159], v[56:59], v[208:211], 0
  ds_read_b64_tr_b16 v[82:83], v26 offset:6144
  s_waitcnt lgkmcnt(11)
  v_mfma_f32_16x16x32_bf16 v[152:155], v[36:39], v[212:215], v[152:155]
  s_waitcnt lgkmcnt(10)
  v_mfma_f32_16x16x32_bf16 v[156:159], v[60:63], v[212:215], v[156:159]
  ds_read_b64_tr_b16 v[84:85], v27 offset:0
  s_waitcnt lgkmcnt(10)
  v_mfma_f32_16x16x32_bf16 v[152:155], v[40:43], v[216:219], v[152:155]
  ds_read_b64_tr_b16 v[86:87], v27 offset:6144
  s_waitcnt lgkmcnt(10)
  v_mfma_f32_16x16x32_bf16 v[156:159], v[64:67], v[216:219], v[156:159]
  s_waitcnt lgkmcnt(9)
  v_mfma_f32_16x16x32_bf16 v[152:155], v[44:47], v[220:223], v[152:155]
  ds_read_b64_tr_b16 v[88:89], v28 offset:0
  s_waitcnt lgkmcnt(9)
  v_mfma_f32_16x16x32_bf16 v[156:159], v[68:71], v[220:223], v[156:159]
  ds_read_b64_tr_b16 v[90:91], v28 offset:6144
  s_waitcnt lgkmcnt(9)
  v_mfma_f32_16x16x32_bf16 v[152:155], v[48:51], v[224:227], v[152:155]
  s_waitcnt lgkmcnt(8)
  v_mfma_f32_16x16x32_bf16 v[156:159], v[72:75], v[224:227], v[156:159]
  ds_read_b64_tr_b16 v[92:93], v29 offset:0
  s_waitcnt lgkmcnt(8)
  v_mfma_f32_16x16x32_bf16 v[152:155], v[52:55], v[228:231], v[152:155]
  ds_read_b64_tr_b16 v[94:95], v29 offset:6144
  s_waitcnt lgkmcnt(8)
  v_mfma_f32_16x16x32_bf16 v[156:159], v[76:79], v[228:231], v[156:159]
  ds_read_b64_tr_b16 v[32:33], v26 offset:128
  s_nop 3
  v_exp_f32 v152, v152
  ds_read_b64_tr_b16 v[34:35], v26 offset:6272
  v_exp_f32 v153, v153
  ds_read_b64_tr_b16 v[36:37], v27 offset:128
  v_exp_f32 v154, v154
  ds_read_b64_tr_b16 v[38:39], v27 offset:6272
  v_exp_f32 v155, v155
  ds_read_b64_tr_b16 v[40:41], v28 offset:128
  v_exp_f32 v156, v156
  ds_read_b64_tr_b16 v[42:43], v28 offset:6272
  v_exp_f32 v157, v157
  ds_read_b64_tr_b16 v[44:45], v29 offset:128
  v_exp_f32 v158, v158
  ds_read_b64_tr_b16 v[46:47], v29 offset:6272
  v_exp_f32 v159, v159
  ds_read_b64_tr_b16 v[48:49], v26 offset:256
  v_cvt_pk_bf16_f32 v232, v152, v153
  ds_read_b64_tr_b16 v[50:51], v26 offset:6400
  v_cvt_pk_bf16_f32 v233, v154, v155
  ds_read_b64_tr_b16 v[52:53], v27 offset:256
  v_cvt_pk_bf16_f32 v234, v156, v157
  ds_read_b64_tr_b16 v[54:55], v27 offset:6400
  v_cvt_pk_bf16_f32 v235, v158, v159
  s_waitcnt lgkmcnt(15)
  s_nop 0
  v_mfma_f32_16x16x32_bf16 v[96:99], v[80:83], v[232:235], v[96:99]
  ds_read_b64_tr_b16 v[56:57], v28 offset:256
  s_waitcnt lgkmcnt(15)
  v_mfma_f32_16x16x32_bf16 v[100:103], v[84:87], v[232:235], v[100:103]
  ds_read_b64_tr_b16 v[58:59], v28 offset:6400
  s_waitcnt lgkmcnt(15)
  v_mfma_f32_16x16x32_bf16 v[104:107], v[88:91], v[232:235], v[104:107]
  ds_read_b64_tr_b16 v[60:61], v29 offset:256
  s_waitcnt lgkmcnt(15)
  v_mfma_f32_16x16x32_bf16 v[108:111], v[92:95], v[232:235], v[108:111]
  ds_read_b64_tr_b16 v[62:63], v29 offset:6400
  s_waitcnt lgkmcnt(14)
  v_mfma_f32_16x16x32_bf16 v[112:115], v[32:35], v[232:235], v[112:115]
  s_waitcnt lgkmcnt(12)
  v_mfma_f32_16x16x32_bf16 v[116:119], v[36:39], v[232:235], v[116:119]
  s_waitcnt lgkmcnt(10)
  v_mfma_f32_16x16x32_bf16 v[120:123], v[40:43], v[232:235], v[120:123]
  s_waitcnt lgkmcnt(8)
  v_mfma_f32_16x16x32_bf16 v[124:127], v[44:47], v[232:235], v[124:127]
  s_waitcnt lgkmcnt(6)
  v_mfma_f32_16x16x32_bf16 v[128:131], v[48:51], v[232:235], v[128:131]
  s_waitcnt lgkmcnt(4)
  v_mfma_f32_16x16x32_bf16 v[132:135], v[52:55], v[232:235], v[132:135]
  s_waitcnt lgkmcnt(2)
  v_mfma_f32_16x16x32_bf16 v[136:139], v[56:59], v[232:235], v[136:139]
  s_waitcnt lgkmcnt(0)
  v_mfma_f32_16x16x32_bf16 v[140:143], v[60:63], v[232:235], v[140:143]
  v_mfma_f32_16x16x32_bf16 v[144:147], v[148:151], v[232:235], v[144:147]
SAFE_RET3:
  s_barrier
  v_lshlrev_b32 v24, 4, v1
  s_mul_i32 s60, s4, 4096
  s_add_u32 s60, s60, 98304
  v_add_u32 v24, s60, v24
  ds_read_b128 v[236:239], v24 offset:0
  ds_read_b128 v[240:243], v24 offset:1024
  ds_read_b128 v[244:247], v24 offset:2048
  ds_read_b128 v[152:155], v24 offset:3072
  v_mul_u32_u24 v25, 114688, v2
  v_lshl_add_u32 v25, v3, 4, v25
  s_lshr_b32 s60, s4, 1
  s_mul_i32 s60, s60, 57344
  s_lshl_b32 s61, s15, 8
  s_add_u32 s60, s60, s61
  s_and_b32 s61, s4, 1
  s_lshl_b32 s61, s61, 7
  s_add_u32 s60, s60, s61
  s_add_u32 s60, s60, 65536
  s_cmp_lg_u32 s36, 0
  s_cbranch_scc1 SAFE_MERGE
MERGED:
  v_cvt_pk_bf16_f32 v32, v96, v97
  v_cvt_pk_bf16_f32 v33, v98, v99
  v_cvt_pk_bf16_f32 v34, v100, v101
  v_cvt_pk_bf16_f32 v35, v102, v103
  v_cvt_pk_bf16_f32 v36, v104, v105
  v_cvt_pk_bf16_f32 v37, v106, v107
  v_cvt_pk_bf16_f32 v38, v108, v109
  v_cvt_pk_bf16_f32 v39, v110, v111
  v_cvt_pk_bf16_f32 v40, v112, v113
  v_cvt_pk_bf16_f32 v41, v114, v115
  v_cvt_pk_bf16_f32 v42, v116, v117
  v_cvt_pk_bf16_f32 v43, v118, v119
  v_cvt_pk_bf16_f32 v44, v120, v121
  v_cvt_pk_bf16_f32 v45, v122, v123
  v_cvt_pk_bf16_f32 v46, v124, v125
  v_cvt_pk_bf16_f32 v47, v126, v127
  v_cvt_pk_bf16_f32 v48, v128, v129
  v_cvt_pk_bf16_f32 v49, v130, v131
  v_cvt_pk_bf16_f32 v50, v132, v133
  v_cvt_pk_bf16_f32 v51, v134, v135
  v_cvt_pk_bf16_f32 v52, v136, v137
  v_cvt_pk_bf16_f32 v53, v138, v139
  v_cvt_pk_bf16_f32 v54, v140, v141
  v_cvt_pk_bf16_f32 v55, v142, v143
  ds_read_b64_tr_b16 v[96:97], v14 offset:0
  ds_read_b64_tr_b16 v[98:99], v14 offset:1536
  ds_read_b64_tr_b16 v[100:101], v14 offset:32
  ds_read_b64_tr_b16 v[102:103], v14 offset:1568
  ds_read_b64_tr_b16 v[104:105], v14 offset:64
  ds_read_b64_tr_b16 v[106:107], v14 offset:1600
  ds_read_b64_tr_b16 v[108:109], v14 offset:3072
  ds_read_b64_tr_b16 v[110:111], v14 offset:4608
  ds_read_b64_tr_b16 v[112:113], v14 offset:3104
  ds_read_b64_tr_b16 v[114:115], v14 offset:4640
  ds_read_b64_tr_b16 v[116:117], v14 offset:3136
  ds_read_b64_tr_b16 v[118:119], v14 offset:4672
  ds_read_b64_tr_b16 v[120:121], v14 offset:6144
  ds_read_b64_tr_b16 v[122:123], v14 offset:7680
  s_waitcnt lgkmcnt(12)
  v_mfma_f32_16x16x32_bf16 v[236:239], v[96:99], v[32:35], v[236:239]
  ds_read_b64_tr_b16 v[124:125], v14 offset:6176
  ds_read_b64_tr_b16 v[126:127], v14 offset:7712
  s_waitcnt lgkmcnt(12)
  v_mfma_f32_16x16x32_bf16 v[240:243], v[100:103], v[32:35], v[240:243]
  ds_read_b64_tr_b16 v[128:129], v14 offset:6208
  ds_read_b64_tr_b16 v[130:131], v14 offset:7744
  s_waitcnt lgkmcnt(12)
  v_mfma_f32_16x16x32_bf16 v[244:247], v[104:107], v[32:35], v[244:247]
  ds_read_b64_tr_b16 v[132:133], v14 offset:9216
  ds_read_b64_tr_b16 v[134:135], v14 offset:10752
  s_waitcnt lgkmcnt(12)
  v_mfma_f32_16x16x32_bf16 v[236:239], v[108:111], v[36:39], v[236:239]
  ds_read_b64_tr_b16 v[136:137], v14 offset:9248
  ds_read_b64_tr_b16 v[138:139], v14 offset:10784
  s_waitcnt lgkmcnt(12)
  v_mfma_f32_16x16x32_bf16 v[240:243], v[112:115], v[36:39], v[240:243]
  ds_read_b64_tr_b16 v[140:141], v14 offset:9280
  ds_read_b64_tr_b16 v[142:143], v14 offset:10816
  s_waitcnt lgkmcnt(12)
  v_mfma_f32_16x16x32_bf16 v[244:247], v[116:119], v[36:39], v[244:247]
  ds_read_b64_tr_b16 v[96:97], v14 offset:12288
  ds_read_b64_tr_b16 v[98:99], v14 offset:13824
  s_waitcnt lgkmcnt(12)
  v_mfma_f32_16x16x32_bf16 v[236:239], v[120:123], v[40:43], v[236:239]
  ds_read_b64_tr_b16 v[100:101], v14 offset:12320
  ds_read_b64_tr_b16 v[102:103], v14 offset:13856
  s_waitcnt lgkmcnt(12)
  v_mfma_f32_16x16x32_bf16 v[240:243], v[124:127], v[40:43], v[240:243]
  ds_read_b64_tr_b16 v[104:105], v14 offset:12352
  ds_read_b64_tr_b16 v[106:107], v14 offset:13888
  s_waitcnt lgkmcnt(12)
  v_mfma_f32_16x16x32_bf16 v[244:247], v[128:131], v[40:43], v[244:247]
  ds_read_b64_tr_b16 v[108:109], v14 offset:15360
  ds_read_b64_tr_b16 v[110:111], v14 offset:16896
  s_waitcnt lgkmcnt(12)
  v_mfma_f32_16x16x32_bf16 v[236:239], v[132:135], v[44:47], v[236:239]
  ds_read_b64_tr_b16 v[112:113], v14 offset:15392
  ds_read_b64_tr_b16 v[114:115], v14 offset:16928
  s_waitcnt lgkmcnt(12)
  v_mfma_f32_16x16x32_bf16 v[240:243], v[136:139], v[44:47], v[240:243]
  ds_read_b64_tr_b16 v[116:117], v14 offset:15424
  ds_read_b64_tr_b16 v[118:119], v14 offset:16960
  s_waitcnt lgkmcnt(12)
  v_mfma_f32_16x16x32_bf16 v[244:247], v[140:143], v[44:47], v[244:247]
  s_waitcnt lgkmcnt(10)
  v_mfma_f32_16x16x32_bf16 v[236:239], v[96:99], v[48:51], v[236:239]
  s_waitcnt lgkmcnt(8)
  v_mfma_f32_16x16x32_bf16 v[240:243], v[100:103], v[48:51], v[240:243]
  s_waitcnt lgkmcnt(6)
  v_mfma_f32_16x16x32_bf16 v[244:247], v[104:107], v[48:51], v[244:247]
  s_waitcnt lgkmcnt(4)
  v_mfma_f32_16x16x32_bf16 v[236:239], v[108:111], v[52:55], v[236:239]
  s_waitcnt lgkmcnt(2)
  v_mfma_f32_16x16x32_bf16 v[240:243], v[112:115], v[52:55], v[240:243]
  s_waitcnt lgkmcnt(0)
  v_mfma_f32_16x16x32_bf16 v[244:247], v[116:119], v[52:55], v[244:247]
  v_add_f32 v86, v144, v152
  v_cvt_pk_bf16_f32 v87, v86, v86
  v_lshlrev_b32 v87, 16, v87
  v_sub_f32 v86, v86, v87
  v_cvt_pk_bf16_f32 v86, v87, v86
  v_min_u32 v86, 0xfffffffe, v86
  v_mov_b32 v87, v17
  v_cvt_pk_bf16_f32 v80, v236, v237
  v_cvt_pk_bf16_f32 v81, v238, v239
  v_min_u32 v80, 0xfffffffe, v80
  v_min_u32 v81, 0xfffffffe, v81
  v_cvt_pk_bf16_f32 v82, v240, v241
  v_cvt_pk_bf16_f32 v83, v242, v243
  v_min_u32 v82, 0xfffffffe, v82
  v_min_u32 v83, 0xfffffffe, v83
  v_cvt_pk_bf16_f32 v84, v244, v245
  v_cvt_pk_bf16_f32 v85, v246, v247
  v_min_u32 v84, 0xfffffffe, v84
  v_min_u32 v85, 0xfffffffe, v85
  s_mov_b32 s17, 0
  s_waitcnt vmcnt(0)
CLRL_24:
  v_cmp_ne_u32 vcc, s14, v15
  s_cbranch_vccz CLRD_25
  s_add_u32 s17, s17, 1
  s_cmp_gt_u32 s17, 20000
  s_cbranch_scc1 CLRD_25
  s_sleep 2
  buffer_load_dword v15, v18, s[56:59], s16 offen sc1
  s_waitcnt vmcnt(0)
  s_branch CLRL_24
CLRD_25:
  buffer_store_dwordx4 v[80:83], v25, s[56:59], s60 offen sc1
  buffer_store_dwordx4 v[84:87], v25, s[56:59], s60 offen offset:64 sc1
  s_endpgm
KK1:
  s_waitcnt vmcnt(0) lgkmcnt(0)
  s_barrier
  v_cvt_pk_bf16_f32 v32, v96, v97
  v_cvt_pk_bf16_f32 v33, v98, v99
  v_cvt_pk_bf16_f32 v34, v100, v101
  v_cvt_pk_bf16_f32 v35, v102, v103
  v_cvt_pk_bf16_f32 v36, v104, v105
  v_cvt_pk_bf16_f32 v37, v106, v107
  v_cvt_pk_bf16_f32 v38, v108, v109
  v_cvt_pk_bf16_f32 v39, v110, v111
  v_cvt_pk_bf16_f32 v40, v112, v113
  v_cvt_pk_bf16_f32 v41, v114, v115
  v_cvt_pk_bf16_f32 v42, v116, v117
  v_cvt_pk_bf16_f32 v43, v118, v119
  v_cvt_pk_bf16_f32 v44, v120, v121
  v_cvt_pk_bf16_f32 v45, v122, v123
  v_cvt_pk_bf16_f32 v46, v124, v125
  v_cvt_pk_bf16_f32 v47, v126, v127
  v_cvt_pk_bf16_f32 v48, v128, v129
  v_cvt_pk_bf16_f32 v49, v130, v131
  v_cvt_pk_bf16_f32 v50, v132, v133
  v_cvt_pk_bf16_f32 v51, v134, v135
  v_cvt_pk_bf16_f32 v52, v136, v137
  v_cvt_pk_bf16_f32 v53, v138, v139
  v_cvt_pk_bf16_f32 v54, v140, v141
  v_cvt_pk_bf16_f32 v55, v142, v143
  ds_read_b64_tr_b16 v[96:97], v14 offset:0
  ds_read_b64_tr_b16 v[98:99], v14 offset:1536
  ds_read_b64_tr_b16 v[100:101], v14 offset:32
  ds_read_b64_tr_b16 v[102:103], v14 offset:1568
  ds_read_b64_tr_b16 v[104:105], v14 offset:64
  ds_read_b64_tr_b16 v[106:107], v14 offset:1600
  ds_read_b64_tr_b16 v[108:109], v14 offset:3072
  ds_read_b64_tr_b16 v[110:111], v14 offset:4608
  ds_read_b64_tr_b16 v[112:113], v14 offset:3104
  ds_read_b64_tr_b16 v[114:115], v14 offset:4640
  ds_read_b64_tr_b16 v[116:117], v14 offset:3136
  ds_read_b64_tr_b16 v[118:119], v14 offset:4672
  ds_read_b64_tr_b16 v[120:121], v14 offset:6144
  ds_read_b64_tr_b16 v[122:123], v14 offset:7680
  s_waitcnt lgkmcnt(12)
  v_mfma_f32_16x16x32_bf16 v[236:239], v[96:99], v[32:35], 0
  ds_read_b64_tr_b16 v[124:125], v14 offset:6176
  ds_read_b64_tr_b16 v[126:127], v14 offset:7712
  s_waitcnt lgkmcnt(12)
  v_mfma_f32_16x16x32_bf16 v[240:243], v[100:103], v[32:35], 0
  ds_read_b64_tr_b16 v[128:129], v14 offset:6208
  ds_read_b64_tr_b16 v[130:131], v14 offset:7744
  s_waitcnt lgkmcnt(12)
  v_mfma_f32_16x16x32_bf16 v[244:247], v[104:107], v[32:35], 0
  ds_read_b64_tr_b16 v[132:133], v14 offset:9216
  ds_read_b64_tr_b16 v[134:135], v14 offset:10752
  s_waitcnt lgkmcnt(12)
  v_mfma_f32_16x16x32_bf16 v[236:239], v[108:111], v[36:39], v[236:239]
  ds_read_b64_tr_b16 v[136:137], v14 offset:9248
  ds_read_b64_tr_b16 v[138:139], v14 offset:10784
  s_waitcnt lgkmcnt(12)
  v_mfma_f32_16x16x32_bf16 v[240:243], v[112:115], v[36:39], v[240:243]
  ds_read_b64_tr_b16 v[140:141], v14 offset:9280
  ds_read_b64_tr_b16 v[142:143], v14 offset:10816
  s_waitcnt lgkmcnt(12)
  v_mfma_f32_16x16x32_bf16 v[244:247], v[116:119], v[36:39], v[244:247]
  ds_read_b64_tr_b16 v[96:97], v14 offset:12288
  ds_read_b64_tr_b16 v[98:99], v14 offset:13824
  s_waitcnt lgkmcnt(12)
  v_mfma_f32_16x16x32_bf16 v[236:239], v[120:123], v[40:43], v[236:239]
  ds_read_b64_tr_b16 v[100:101], v14 offset:12320
  ds_read_b64_tr_b16 v[102:103], v14 offset:13856
  s_waitcnt lgkmcnt(12)
  v_mfma_f32_16x16x32_bf16 v[240:243], v[124:127], v[40:43], v[240:243]
  ds_read_b64_tr_b16 v[104:105], v14 offset:12352
  ds_read_b64_tr_b16 v[106:107], v14 offset:13888
  s_waitcnt lgkmcnt(12)
  v_mfma_f32_16x16x32_bf16 v[244:247], v[128:131], v[40:43], v[244:247]
  ds_read_b64_tr_b16 v[108:109], v14 offset:15360
  ds_read_b64_tr_b16 v[110:111], v14 offset:16896
  s_waitcnt lgkmcnt(12)
  v_mfma_f32_16x16x32_bf16 v[236:239], v[132:135], v[44:47], v[236:239]
  ds_read_b64_tr_b16 v[112:113], v14 offset:15392
  ds_read_b64_tr_b16 v[114:115], v14 offset:16928
  s_waitcnt lgkmcnt(12)
  v_mfma_f32_16x16x32_bf16 v[240:243], v[136:139], v[44:47], v[240:243]
  ds_read_b64_tr_b16 v[116:117], v14 offset:15424
  ds_read_b64_tr_b16 v[118:119], v14 offset:16960
  s_waitcnt lgkmcnt(12)
  v_mfma_f32_16x16x32_bf16 v[244:247], v[140:143], v[44:47], v[244:247]
  s_waitcnt lgkmcnt(10)
  v_mfma_f32_16x16x32_bf16 v[236:239], v[96:99], v[48:51], v[236:239]
  s_waitcnt lgkmcnt(8)
  v_mfma_f32_16x16x32_bf16 v[240:243], v[100:103], v[48:51], v[240:243]
  s_waitcnt lgkmcnt(6)
  v_mfma_f32_16x16x32_bf16 v[244:247], v[104:107], v[48:51], v[244:247]
  s_waitcnt lgkmcnt(4)
  v_mfma_f32_16x16x32_bf16 v[236:239], v[108:111], v[52:55], v[236:239]
  s_waitcnt lgkmcnt(2)
  v_mfma_f32_16x16x32_bf16 v[240:243], v[112:115], v[52:55], v[240:243]
  s_waitcnt lgkmcnt(0)
  v_mfma_f32_16x16x32_bf16 v[244:247], v[116:119], v[52:55], v[244:247]
  v_lshlrev_b32 v24, 4, v1
  s_mul_i32 s60, s4, 4096
  s_add_u32 s60, s60, 98304
  v_add_u32 v24, s60, v24
  ds_write_b128 v24, v[236:239] offset:0
  s_nop 0
  ds_write_b128 v24, v[240:243] offset:1024
  s_nop 0
  ds_write_b128 v24, v[244:247] offset:2048
  v_mov_b32 v145, v17
  ds_write_b128 v24, v[144:147] offset:3072
  s_waitcnt lgkmcnt(0)
  s_barrier
  s_endpgm
SAFE_IN0:
  v_mov_b32 v96, 0
  v_mov_b32 v97, 0
  v_mov_b32 v98, 0
  v_mov_b32 v99, 0
  v_mov_b32 v100, 0
  v_mov_b32 v101, 0
  v_mov_b32 v102, 0
  v_mov_b32 v103, 0
  v_mov_b32 v104, 0
  v_mov_b32 v105, 0
  v_mov_b32 v106, 0
  v_mov_b32 v107, 0
  v_mov_b32 v108, 0
  v_mov_b32 v109, 0
  v_mov_b32 v110, 0
  v_mov_b32 v111, 0
  v_mov_b32 v112, 0
  v_mov_b32 v113, 0
  v_mov_b32 v114, 0
  v_mov_b32 v115, 0
  v_mov_b32 v116, 0
  v_mov_b32 v117, 0
  v_mov_b32 v118, 0
  v_mov_b32 v119, 0
  v_mov_b32 v120, 0
  v_mov_b32 v121, 0
  v_mov_b32 v122, 0
  v_mov_b32 v123, 0
  v_mov_b32 v124, 0
  v_mov_b32 v125, 0
  v_mov_b32 v126, 0
  v_mov_b32 v127, 0
  v_mov_b32 v128, 0
  v_mov_b32 v129, 0
  v_mov_b32 v130, 0
  v_mov_b32 v131, 0
  v_mov_b32 v132, 0
  v_mov_b32 v133, 0
  v_mov_b32 v134, 0
  v_mov_b32 v135, 0
  v_mov_b32 v136, 0
  v_mov_b32 v137, 0
  v_mov_b32 v138, 0
  v_mov_b32 v139, 0
  v_mov_b32 v140, 0
  v_mov_b32 v141, 0
  v_mov_b32 v142, 0
  v_mov_b32 v143, 0
  v_mov_b32 v144, 0
  v_mov_b32 v145, 0
  v_mov_b32 v146, 0
  v_mov_b32 v147, 0
  v_mov_b32 v17, 0xff800000
  s_mov_b32 s37, 0
  s_branch SAFE_BODY
SAFE_OUT0:
  s_waitcnt lgkmcnt(0)
  s_branch SAFE_RET0
SAFE_IN1:
  s_mov_b32 s37, 1
  s_branch SAFE_BODY
SAFE_OUT1:
  s_mul_i32 s60, s4, 3072
  s_add_u32 s60, s60, 98304
  v_add_u32 v13, s60, v10
  v_add_u32 v15, s60, v11
  ds_read_b128 v[64:67], v13 offset:0
  ds_read_b128 v[68:71], v15 offset:0
  ds_read_b128 v[72:75], v13 offset:256
  ds_read_b128 v[76:79], v15 offset:256
  ds_read_b128 v[80:83], v13 offset:512
  ds_read_b128 v[84:87], v15 offset:512
  s_waitcnt lgkmcnt(0)
  s_branch SAFE_RET1
SAFE_IN2:
  s_mov_b32 s37, 2
  s_branch SAFE_BODY
SAFE_OUT2:
  s_and_b32 s60, s3, 1
  s_mul_i32 s60, s60, 3072
  s_add_u32 s60, s60, 110592
  v_add_u32 v13, s60, v10
  v_add_u32 v15, s60, v11
  ds_read_b128 v[64:67], v13 offset:0
  ds_read_b128 v[68:71], v15 offset:0
  ds_read_b128 v[72:75], v13 offset:256
  ds_read_b128 v[76:79], v15 offset:256
  ds_read_b128 v[80:83], v13 offset:512
  ds_read_b128 v[84:87], v15 offset:512
  s_waitcnt lgkmcnt(0)
  s_branch SAFE_RET2
SAFE_IN3:
  s_mov_b32 s37, 3
  s_branch SAFE_BODY
SAFE_OUT3:
  s_waitcnt lgkmcnt(0)
  s_branch SAFE_RET3
SAFE_BODY:
  s_waitcnt lgkmcnt(0)
  s_nop 7
  s_nop 7
  v_add_u32 v24, s12, v8
  v_add_u32 v25, s12, v9
  v_add_u32 v26, s12, v20
  v_add_u32 v27, s12, v21
  v_add_u32 v28, s12, v22
  v_add_u32 v29, s12, v23
  ds_read_b128 v[32:35], v24 offset:0
  ds_read_b128 v[56:59], v24 offset:6144
  ds_read_b128 v[36:39], v25 offset:0
  ds_read_b128 v[60:63], v25 offset:6144
  ds_read_b128 v[40:43], v24 offset:128
  ds_read_b128 v[64:67], v24 offset:6272
  ds_read_b128 v[44:47], v25 offset:128
  ds_read_b128 v[68:71], v25 offset:6272
  ds_read_b128 v[48:51], v24 offset:256
  ds_read_b128 v[72:75], v24 offset:6400
  ds_read_b128 v[52:55], v25 offset:256
  ds_read_b128 v[76:79], v25 offset:6400
  s_waitcnt lgkmcnt(11)
  v_mfma_f32_16x16x32_bf16 v[152:155], v[32:35], v[208:211], 0
  s_waitcnt lgkmcnt(10)
  v_mfma_f32_16x16x32_bf16 v[156:159], v[56:59], v[208:211], 0
  s_waitcnt lgkmcnt(9)
  v_mfma_f32_16x16x32_bf16 v[152:155], v[36:39], v[212:215], v[152:155]
  s_waitcnt lgkmcnt(8)
  v_mfma_f32_16x16x32_bf16 v[156:159], v[60:63], v[212:215], v[156:159]
  s_waitcnt lgkmcnt(7)
  v_mfma_f32_16x16x32_bf16 v[152:155], v[40:43], v[216:219], v[152:155]
  s_waitcnt lgkmcnt(6)
  v_mfma_f32_16x16x32_bf16 v[156:159], v[64:67], v[216:219], v[156:159]
  s_waitcnt lgkmcnt(5)
  v_mfma_f32_16x16x32_bf16 v[152:155], v[44:47], v[220:223], v[152:155]
  s_waitcnt lgkmcnt(4)
  v_mfma_f32_16x16x32_bf16 v[156:159], v[68:71], v[220:223], v[156:159]
  s_waitcnt lgkmcnt(3)
  v_mfma_f32_16x16x32_bf16 v[152:155], v[48:51], v[224:227], v[152:155]
  s_waitcnt lgkmcnt(2)
  v_mfma_f32_16x16x32_bf16 v[156:159], v[72:75], v[224:227], v[156:159]
  s_waitcnt lgkmcnt(1)
  v_mfma_f32_16x16x32_bf16 v[152:155], v[52:55], v[228:231], v[152:155]
  s_waitcnt lgkmcnt(0)
  v_mfma_f32_16x16x32_bf16 v[156:159], v[76:79], v[228:231], v[156:159]
  s_nop 7
  s_nop 7
  ds_read_b64_tr_b16 v[32:33], v26 offset:0
  ds_read_b64_tr_b16 v[34:35], v26 offset:6144
  ds_read_b64_tr_b16 v[36:37], v27 offset:0
  ds_read_b64_tr_b16 v[38:39], v27 offset:6144
  ds_read_b64_tr_b16 v[40:41], v28 offset:0
  ds_read_b64_tr_b16 v[42:43], v28 offset:6144
  ds_read_b64_tr_b16 v[44:45], v29 offset:0
  ds_read_b64_tr_b16 v[46:47], v29 offset:6144
  ds_read_b64_tr_b16 v[48:49], v26 offset:128
  ds_read_b64_tr_b16 v[50:51], v26 offset:6272
  ds_read_b64_tr_b16 v[52:53], v27 offset:128
  ds_read_b64_tr_b16 v[54:55], v27 offset:6272
  ds_read_b64_tr_b16 v[56:57], v28 offset:128
  ds_read_b64_tr_b16 v[58:59], v28 offset:6272
  ds_read_b64_tr_b16 v[60:61], v29 offset:128
  ds_read_b64_tr_b16 v[62:63], v29 offset:6272
  ds_read_b64_tr_b16 v[64:65], v26 offset:256
  ds_read_b64_tr_b16 v[66:67], v26 offset:6400
  ds_read_b64_tr_b16 v[68:69], v27 offset:256
  ds_read_b64_tr_b16 v[70:71], v27 offset:6400
  ds_read_b64_tr_b16 v[72:73], v28 offset:256
  ds_read_b64_tr_b16 v[74:75], v28 offset:6400
  ds_read_b64_tr_b16 v[76:77], v29 offset:256
  ds_read_b64_tr_b16 v[78:79], v29 offset:6400
  v_max3_f32 v13, v152, v153, v154
  v_max3_f32 v13, v13, v155, v156
  v_max3_f32 v13, v13, v157, v158
  v_max_f32 v13, v13, v159
  v_mov_b32 v16, v13
  s_nop 1
  v_permlane32_swap_b32 v13, v16
  v_max_f32 v13, v13, v16
  v_mov_b32 v16, v13
  s_nop 1
  v_permlane16_swap_b32 v13, v16
  v_max_f32 v13, v13, v16
  v_max_f32 v13, v13, v17
  v_sub_f32 v16, v17, v13
  v_exp_f32 v16, v16
  v_mov_b32 v17, v13
  v_sub_f32 v152, v152, v13
  v_sub_f32 v153, v153, v13
  v_sub_f32 v154, v154, v13
  v_sub_f32 v155, v155, v13
  v_sub_f32 v156, v156, v13
  v_sub_f32 v157, v157, v13
  v_sub_f32 v158, v158, v13
  v_sub_f32 v159, v159, v13
  v_exp_f32 v152, v152
  v_exp_f32 v153, v153
  v_exp_f32 v154, v154
  v_exp_f32 v155, v155
  v_exp_f32 v156, v156
  v_exp_f32 v157, v157
  v_exp_f32 v158, v158
  v_exp_f32 v159, v159
  v_cvt_pk_bf16_f32 v232, v152, v153
  v_cvt_pk_bf16_f32 v233, v154, v155
  v_cvt_pk_bf16_f32 v234, v156, v157
  v_cvt_pk_bf16_f32 v235, v158, v159
  v_mul_f32 v96, v96, v16
  v_mul_f32 v97, v97, v16
  v_mul_f32 v98, v98, v16
  v_mul_f32 v99, v99, v16
  v_mul_f32 v100, v100, v16
  v_mul_f32 v101, v101, v16
  v_mul_f32 v102, v102, v16
  v_mul_f32 v103, v103, v16
  v_mul_f32 v104, v104, v16
  v_mul_f32 v105, v105, v16
  v_mul_f32 v106, v106, v16
  v_mul_f32 v107, v107, v16
  v_mul_f32 v108, v108, v16
  v_mul_f32 v109, v109, v16
  v_mul_f32 v110, v110, v16
  v_mul_f32 v111, v111, v16
  v_mul_f32 v112, v112, v16
  v_mul_f32 v113, v113, v16
  v_mul_f32 v114, v114, v16
  v_mul_f32 v115, v115, v16
  v_mul_f32 v116, v116, v16
  v_mul_f32 v117, v117, v16
  v_mul_f32 v118, v118, v16
  v_mul_f32 v119, v119, v16
  v_mul_f32 v120, v120, v16
  v_mul_f32 v121, v121, v16
  v_mul_f32 v122, v122, v16
  v_mul_f32 v123, v123, v16
  v_mul_f32 v124, v124, v16
  v_mul_f32 v125, v125, v16
  v_mul_f32 v126, v126, v16
  v_mul_f32 v127, v127, v16
  v_mul_f32 v128, v128, v16
  v_mul_f32 v129, v129, v16
  v_mul_f32 v130, v130, v16
  v_mul_f32 v131, v131, v16
  v_mul_f32 v132, v132, v16
  v_mul_f32 v133, v133, v16
  v_mul_f32 v134, v134, v16
  v_mul_f32 v135, v135, v16
  v_mul_f32 v136, v136, v16
  v_mul_f32 v137, v137, v16
  v_mul_f32 v138, v138, v16
  v_mul_f32 v139, v139, v16
  v_mul_f32 v140, v140, v16
  v_mul_f32 v141, v141, v16
  v_mul_f32 v142, v142, v16
  v_mul_f32 v143, v143, v16
  v_mul_f32 v144, v144, v16
  v_mul_f32 v145, v145, v16
  v_mul_f32 v146, v146, v16
  v_mul_f32 v147, v147, v16
  s_waitcnt lgkmcnt(15)
  v_mfma_f32_16x16x32_bf16 v[96:99], v[32:35], v[232:235], v[96:99]
  s_waitcnt lgkmcnt(15)
  v_mfma_f32_16x16x32_bf16 v[100:103], v[36:39], v[232:235], v[100:103]
  s_waitcnt lgkmcnt(15)
  v_mfma_f32_16x16x32_bf16 v[104:107], v[40:43], v[232:235], v[104:107]
  s_waitcnt lgkmcnt(15)
  v_mfma_f32_16x16x32_bf16 v[108:111], v[44:47], v[232:235], v[108:111]
  s_waitcnt lgkmcnt(14)
  v_mfma_f32_16x16x32_bf16 v[112:115], v[48:51], v[232:235], v[112:115]
  s_waitcnt lgkmcnt(12)
  v_mfma_f32_16x16x32_bf16 v[116:119], v[52:55], v[232:235], v[116:119]
  s_waitcnt lgkmcnt(10)
  v_mfma_f32_16x16x32_bf16 v[120:123], v[56:59], v[232:235], v[120:123]
  s_waitcnt lgkmcnt(8)
  v_mfma_f32_16x16x32_bf16 v[124:127], v[60:63], v[232:235], v[124:127]
  s_waitcnt lgkmcnt(6)
  v_mfma_f32_16x16x32_bf16 v[128:131], v[64:67], v[232:235], v[128:131]
  s_waitcnt lgkmcnt(4)
  v_mfma_f32_16x16x32_bf16 v[132:135], v[68:71], v[232:235], v[132:135]
  s_waitcnt lgkmcnt(2)
  v_mfma_f32_16x16x32_bf16 v[136:139], v[72:75], v[232:235], v[136:139]
  s_waitcnt lgkmcnt(0)
  v_mfma_f32_16x16x32_bf16 v[140:143], v[76:79], v[232:235], v[140:143]
  v_mfma_f32_16x16x32_bf16 v[144:147], v[148:151], v[232:235], v[144:147]
  s_nop 7
  s_nop 7
  s_cmp_eq_u32 s37, 0
  s_cbranch_scc1 SAFE_OUT0
  s_cmp_eq_u32 s37, 1
  s_cbranch_scc1 SAFE_OUT1
  s_cmp_eq_u32 s37, 2
  s_cbranch_scc1 SAFE_OUT2
  s_branch SAFE_OUT3
SAFE_MERGE:
  s_waitcnt lgkmcnt(0)
  v_max_f32 v13, v17, v153
  v_sub_f32 v16, v17, v13
  v_exp_f32 v16, v16
  v_sub_f32 v154, v153, v13
  v_exp_f32 v154, v154
  v_mul_f32 v96, v96, v16
  v_mul_f32 v97, v97, v16
  v_mul_f32 v98, v98, v16
  v_mul_f32 v99, v99, v16
  v_mul_f32 v100, v100, v16
  v_mul_f32 v101, v101, v16
  v_mul_f32 v102, v102, v16
  v_mul_f32 v103, v103, v16
  v_mul_f32 v104, v104, v16
  v_mul_f32 v105, v105, v16
  v_mul_f32 v106, v106, v16
  v_mul_f32 v107, v107, v16
  v_mul_f32 v108, v108, v16
  v_mul_f32 v109, v109, v16
  v_mul_f32 v110, v110, v16
  v_mul_f32 v111, v111, v16
  v_mul_f32 v112, v112, v16
  v_mul_f32 v113, v113, v16
  v_mul_f32 v114, v114, v16
  v_mul_f32 v115, v115, v16
  v_mul_f32 v116, v116, v16
  v_mul_f32 v117, v117, v16
  v_mul_f32 v118, v118, v16
  v_mul_f32 v119, v119, v16
  v_mul_f32 v120, v120, v16
  v_mul_f32 v121, v121, v16
  v_mul_f32 v122, v122, v16
  v_mul_f32 v123, v123, v16
  v_mul_f32 v124, v124, v16
  v_mul_f32 v125, v125, v16
  v_mul_f32 v126, v126, v16
  v_mul_f32 v127, v127, v16
  v_mul_f32 v128, v128, v16
  v_mul_f32 v129, v129, v16
  v_mul_f32 v130, v130, v16
  v_mul_f32 v131, v131, v16
  v_mul_f32 v132, v132, v16
  v_mul_f32 v133, v133, v16
  v_mul_f32 v134, v134, v16
  v_mul_f32 v135, v135, v16
  v_mul_f32 v136, v136, v16
  v_mul_f32 v137, v137, v16
  v_mul_f32 v138, v138, v16
  v_mul_f32 v139, v139, v16
  v_mul_f32 v140, v140, v16
  v_mul_f32 v141, v141, v16
  v_mul_f32 v142, v142, v16
  v_mul_f32 v143, v143, v16
  v_mul_f32 v144, v144, v16
  v_mul_f32 v236, v236, v154
  v_mul_f32 v237, v237, v154
  v_mul_f32 v238, v238, v154
  v_mul_f32 v239, v239, v154
  v_mul_f32 v240, v240, v154
  v_mul_f32 v241, v241, v154
  v_mul_f32 v242, v242, v154
  v_mul_f32 v243, v243, v154
  v_mul_f32 v244, v244, v154
  v_mul_f32 v245, v245, v154
  v_mul_f32 v246, v246, v154
  v_mul_f32 v247, v247, v154
  v_mul_f32 v152, v152, v154
  v_or_b32 v13, 1, v13
  v_min_u32 v17, 0xfffffffe, v13
  s_nop 3
  s_branch MERGED
K_END:
  s_endpgm
.section .rodata,"a"
.p2align 6
.amdhsa_kernel standalone__detection_seg_mask2former__vision_kernel
  .amdhsa_next_free_vgpr 248
  .amdhsa_next_free_sgpr 102
  .amdhsa_accum_offset 248
  .amdhsa_group_segment_fixed_size 0
  .amdhsa_kernarg_size 96
  .amdhsa_user_sgpr_count 2
  .amdhsa_user_sgpr_kernarg_segment_ptr 1
  .amdhsa_system_sgpr_workgroup_id_x 1
.end_amdhsa_kernel
```
